```python
import torch

def _softmax(x, axis=-1):
    return torch.softmax(x, dim=axis)
def _gelu(x):
    return torch.nn.functional.gelu(x, approximate="tanh")
def _silu(x):
    return torch.nn.functional.silu(x)
def _sigmoid(x):
    return torch.sigmoid(x)
def _layernorm(x, axis=-1, eps=1e-5):
    m = x.mean(dim=axis, keepdim=True)
    v = x.var(dim=axis, keepdim=True, unbiased=False)
    return (x - m) / torch.sqrt(v + eps)
def _scatter_add(tgt, idx, src, axis=0):
    return tgt.clone().index_add_(axis, idx, src)
def _segment_sum(src, seg, n):
    out = torch.zeros((n,) + src.shape[1:], dtype=src.dtype)
    return out.index_add_(0, seg, src)
def _pad(x, pw):
    flat = tuple(v for pair in reversed(pw) for v in pair)
    return torch.nn.functional.pad(x, flat)

kernel_name = 'parallel_sum__linear_attn_block__moe_arch_mod__prompt'

def setup_inputs():

    _w = (lambda a: (lambda t: t.to(torch.bfloat16) if t.is_floating_point() else t)(torch.as_tensor(a)))
    def _A_setup():
        B, S, D = 1, 2048, 1024
        return {
            "x": _w((lambda *s: torch.randn(*s, dtype=torch.bfloat16) * 0.05)(B, S, D)),
            "wqkv": _w((lambda *s: torch.randn(*s, dtype=torch.bfloat16) * 0.4)(D, 3 * D)),
            "wo": _w((lambda *s: torch.randn(*s, dtype=torch.bfloat16) * 0.2)(D, D)),
        }
    _A_in = _A_setup()

    def _B_setup():
        B, S, D, F, C = 1, 2048, 1024, 3584, 1
        return {
            "x": _w((lambda *s: torch.randn(*s, dtype=torch.bfloat16) * 0.05)(B, S, D)),
            "w_r": _w((lambda *s: torch.randn(*s, dtype=torch.bfloat16) * 0.05)(D)),
            "w_gate": _w((lambda *s: torch.randn(*s, dtype=torch.bfloat16) * 0.05)(D, F)),
            "w_up": _w((lambda *s: torch.randn(*s, dtype=torch.bfloat16) * 0.05)(D, F)),
            "w_down": _w((lambda *s: torch.randn(*s, dtype=torch.bfloat16) * 0.05)(F, D)),
        }
    _B_in = _B_setup()

    return {
        "A_x": _A_in["x"],
        "A_wqkv": _A_in["wqkv"],
        "A_wo": _A_in["wo"],
        "B_x": _B_in["x"],
        "B_w_r": _B_in["w_r"],
        "B_w_gate": _B_in["w_gate"],
        "B_w_up": _B_in["w_up"],
        "B_w_down": _B_in["w_down"],
    }

def reference(A_x, A_wqkv, A_wo, B_x, B_w_r, B_w_gate, B_w_up, B_w_down):
    def _A_ref(x, wqkv, wo):
        B, S, D = x.shape
        H = 32; Dh = D // H
        qkv = (lambda x, *d: x.permute(*d))((x @ wqkv).reshape(B, S, 3, H, Dh), 2, 0, 3, 1, 4)
        q, k, v = qkv[0], qkv[1], qkv[2]
        phi = lambda t: torch.where(t > 0, t + 1, torch.exp(t)) + 1e-6
        pq, pk = phi(q), phi(k)
        kv = torch.einsum("bhsd,bhse->bhde", pk, v)
        z = torch.einsum("bhsd->bhd", pk)
        num = torch.einsum("bhqd,bhde->bhqe", pq, kv)
        den = torch.einsum("bhqd,bhd->bhq", pq, z)[..., None] + 1e-6
        o = num / den
        return (lambda x, *d: x.permute(*d))(o, 0, 2, 1, 3).reshape(B, S, D) @ wo

    def _B_ref(x, w_r, w_gate, w_up, w_down):
        B, S, D = x.shape
        C = 1
        r = x @ w_r
        idx = torch.argsort(-r, axis=-1)[:, :C]
        idx_e = (lambda x, n, axis: torch.repeat_interleave(x, n, dim=axis))(idx.reshape(B, C, 1), D, axis=2)
        x_sel = (lambda x, i, axis: torch.take_along_dim(x, i, dim=axis))(x, idx_e, axis=1)
        g = _silu(x_sel @ w_gate)
        u = x_sel @ w_up
        y = (g * u) @ w_down
        r_sel = _sigmoid((lambda x, i, axis: torch.take_along_dim(x, i, dim=axis))(r, idx, axis=1))
        y = y * r_sel.reshape(B, C, 1)
        b_off = (torch.arange(B) * S).reshape(B, 1)
        flat_idx = (idx + b_off).reshape(B * C)
        zero = (x * 0.0).reshape(B * S, D)
        upd = _scatter_add(zero, flat_idx, y.reshape(B * C, D), axis=0)
        return x + upd.reshape(B, S, D)

    x = A_x
    xn = _layernorm(x, axis=-1)
    return x + _A_ref(xn, A_wqkv, A_wo) + _B_ref(xn, B_w_r, B_w_gate, B_w_up, B_w_down)
```

```asm
; @launch grid=(256,1,1) block=(512,1,1) lds=163840
.amdgcn_target "amdgcn-amd-amdhsa--gfx950"
.text
.globl parallel_sum__linear_attn_block__moe_arch_mod__prompt_kernel
.p2align 8
.type parallel_sum__linear_attn_block__moe_arch_mod__prompt_kernel,@function
parallel_sum__linear_attn_block__moe_arch_mod__prompt_kernel:
    s_cmp_ge_u32 s2, 256
    s_cbranch_scc1 L_end
    s_load_dwordx4 s[4:7], s[0:1], 0
    s_load_dwordx8 s[72:79], s[0:1], 32
    s_load_dwordx2 s[80:81], s[0:1], 64
    s_load_dwordx2 s[82:83], s[0:1], 80
    s_load_dwordx2 s[84:85], s[0:1], 16
    s_load_dwordx2 s[68:69], s[0:1], 72
    s_getpc_b64 s[30:31]
L_pc:
    v_lshlrev_b32 v3, 1, v0
    s_lshr_b32 s32, s2, 3
    s_lshl_b32 s32, s32, 10
    v_add_u32 v3, s32, v3
    s_sub_u32 s30, s30, L_pc-parallel_sum__linear_attn_block__moe_arch_mod__prompt_kernel
    v_min_u32 v3, L_end-parallel_sum__linear_attn_block__moe_arch_mod__prompt_kernel, v3
    s_subb_u32 s31, s31, 0
    s_mov_b64 exec, 1
    global_load_dword v245, v3, s[30:31]
    s_mov_b64 exec, -1
    s_and_b32 s20, s2, 7
    s_lshr_b32 s21, s2, 3
    s_and_b32 s24, s20, 1
    s_mul_i32 s23, s21, 43
    s_lshr_b32 s23, s23, 8
    s_mul_i32 s30, s23, 6
    s_sub_u32 s22, s21, s30
    s_lshl_b32 s30, s24, 1
    s_add_u32 s30, s30, s22
    s_mul_i32 s31, s24, 7
    s_add_u32 s22, s22, s31
    s_cmp_ge_u32 s21, 24
    s_cselect_b32 s22, 6, s22
    s_cselect_b32 s23, s30, s23
    s_cmp_ge_u32 s21, 26
    s_cselect_b32 s57, 1, 0
    s_lshr_b32 s31, s20, 1
    s_lshl_b32 s30, s31, 2
    s_add_u32 s23, s23, s30
    s_mul_i32 s58, s20, 6
    s_add_u32 s58, s58, s21
    s_sub_u32 s58, s58, 26
    s_and_b32 s28, s21, 3
    s_lshl_b32 s30, s24, 3
    s_add_u32 s28, s28, s30
    s_and_b32 s30, s20, 2
    s_lshl_b32 s30, s30, 1
    s_add_u32 s28, s28, s30
    s_and_b32 s29, s20, 4
    s_lshl_b32 s29, s29, 1
    s_lshr_b32 s30, s21, 2
    s_add_u32 s29, s29, s30
    v_lshrrev_b32 v1, 6, v0
    v_and_b32 v0, 63, v0
    v_lshlrev_b32 v2, 4, v0
    v_readfirstlane_b32 s25, v1
    s_mov_b32 s10, 0x400000
    s_mov_b32 s11, 0x20000
    s_mov_b32 s14, 0x600000
    s_mov_b32 s15, 0x20000
    s_mov_b32 s18, 0x10000000
    s_mov_b32 s19, 0x20000
    s_cmp_ge_u32 s25, 4
    s_cbranch_scc1 L_loader
    s_setprio 2
    s_lshr_b32 s26, s25, 1
    s_and_b32 s27, s25, 1
    s_lshl_b32 s33, s2, 3
    s_lshl_b32 s31, s25, 1
    s_add_u32 s33, s33, s31
    s_lshl_b32 s30, s33, 11
    s_waitcnt lgkmcnt(0)
    s_mov_b32 s8, s4
    s_and_b32 s9, s5, 0xffff
    s_mov_b32 s12, s6
    s_and_b32 s13, s7, 0xffff
    s_mov_b32 s16, s82
    s_and_b32 s17, s83, 0xffff
    buffer_load_dwordx4 v[64:67], v2, s[8:11], s30 offen offset:0
    buffer_load_dwordx4 v[68:71], v2, s[8:11], s30 offen offset:1024
    buffer_load_dwordx4 v[72:75], v2, s[8:11], s30 offen offset:2048
    buffer_load_dwordx4 v[76:79], v2, s[8:11], s30 offen offset:3072
    s_mov_b32 s40, s72
    s_and_b32 s41, s73, 0xffff
    s_mov_b32 s42, 0x800
    s_mov_b32 s43, 0x20000
    buffer_load_dwordx4 v[112:115], v2, s[40:43], 0 offen
    buffer_load_dwordx4 v[116:119], v2, s[40:43], 0 offen offset:1024
    s_cmp_eq_u32 s57, 1
    s_cbranch_scc1 L_moe_w
    s_branch L_crest
L_loader:
    s_cmp_ge_u32 s25, 6
    s_cbranch_scc1 L_service
    s_cmp_eq_u32 s57, 1
    s_cbranch_scc1 L_moe_k
    s_sub_u32 s26, s25, 4
    s_mul_i32 s30, s22, 160
    s_mul_i32 s31, s26, 80
    s_add_u32 s30, s30, s31
    v_lshrrev_b32 v1, 3, v0
    v_add_u32 v3, s30, v1
    v_lshlrev_b32 v3, 11, v3
    v_and_b32 v4, 7, v0
    v_lshrrev_b32 v5, 4, v0
    v_xor_b32 v6, v4, v5
    v_lshlrev_b32 v6, 4, v6
    v_add_u32 v16, v3, v6
    v_xor_b32 v17, 64, v16
    v_add_u32 v17, 16384, v17
    v_add_u32 v18, 32768, v16
    v_add_u32 v19, 32768, v17
    v_add_u32 v20, 65536, v16
    v_add_u32 v21, 65536, v17
    v_add_u32 v22, 98304, v16
    v_add_u32 v23, 98304, v17
    v_add_u32 v24, 131072, v16
    v_add_u32 v25, 131072, v17
    s_lshl_b32 s30, s26, 5
    v_add_u32 v3, s30, v1
    v_mul_u32_u24 v3, 6144, v3
    v_and_b32 v6, 1, v5
    v_lshlrev_b32 v6, 2, v6
    v_xor_b32 v6, v4, v6
    v_lshlrev_b32 v6, 4, v6
    v_add_u32 v3, v3, v6
    s_lshl_b32 s30, s23, 7
    v_add_u32 v28, s30, v3
    v_xor_b32 v29, 32, v28
    v_add_u32 v29, 49152, v29
    v_add_u32 v39, 102400, v29
    v_add_u32 v38, 102400, v28
    v_add_u32 v37, 4096, v29
    v_add_u32 v36, 4096, v28
    v_add_u32 v35, 100352, v29
    v_add_u32 v34, 100352, v28
    v_add_u32 v33, 2048, v29
    v_add_u32 v32, 2048, v28
    v_add_u32 v31, 98304, v29
    v_add_u32 v30, 98304, v28
    v_xor_b32 v28, 128, v28
    v_xor_b32 v29, 128, v29
    v_xor_b32 v30, 128, v30
    v_xor_b32 v31, 128, v31
    s_mul_i32 s32, s26, 10240
    s_lshl_b32 s33, s26, 12
    s_add_u32 s33, s33, 20480
    s_mov_b32 s34, 0
    s_mov_b32 s35, 0
    s_mov_b32 s36, 0
    s_mov_b32 s31, 0
    s_waitcnt lgkmcnt(0)
    s_mov_b32 s8, s4
    s_and_b32 s9, s5, 0xffff
    s_mov_b32 s12, s6
    s_and_b32 s13, s7, 0xffff
    s_mov_b32 s16, s82
    s_and_b32 s17, s83, 0xffff
L_lloop:
    s_cmp_lt_u32 s31, 2
    s_cbranch_scc1 L_lissue
    s_waitcnt vmcnt(22)
    s_barrier
L_lissue:
    s_add_u32 s37, s36, s32
    s_add_u32 s38, s36, s33
    s_add_u32 m0, s37, 0
    s_nop 0
    buffer_load_dwordx4 v16, s[8:11], s34 offen lds
    s_add_u32 m0, s37, 1024
    s_nop 0
    buffer_load_dwordx4 v17, s[8:11], s34 offen lds
    s_add_u32 m0, s37, 2048
    s_nop 0
    buffer_load_dwordx4 v18, s[8:11], s34 offen lds
    s_add_u32 m0, s37, 3072
    s_nop 0
    buffer_load_dwordx4 v19, s[8:11], s34 offen lds
    s_add_u32 m0, s37, 4096
    s_nop 0
    buffer_load_dwordx4 v20, s[8:11], s34 offen lds
    s_add_u32 m0, s37, 5120
    s_nop 0
    buffer_load_dwordx4 v21, s[8:11], s34 offen lds
    s_add_u32 m0, s37, 6144
    s_nop 0
    buffer_load_dwordx4 v22, s[8:11], s34 offen lds
    s_add_u32 m0, s37, 7168
    s_nop 0
    buffer_load_dwordx4 v23, s[8:11], s34 offen lds
    s_add_u32 m0, s37, 8192
    s_nop 0
    buffer_load_dwordx4 v24, s[8:11], s34 offen lds
    s_add_u32 m0, s37, 9216
    s_nop 0
    buffer_load_dwordx4 v25, s[8:11], s34 offen lds
    s_add_u32 m0, s38, 0
    s_nop 0
    buffer_load_dwordx4 v28, s[12:15], s35 offen lds
    s_add_u32 m0, s38, 1024
    s_nop 0
    buffer_load_dwordx4 v29, s[12:15], s35 offen lds
    s_add_u32 m0, s38, 2048
    s_nop 0
    buffer_load_dwordx4 v30, s[12:15], s35 offen lds
    s_add_u32 m0, s38, 3072
    s_nop 0
    buffer_load_dwordx4 v31, s[12:15], s35 offen lds
    s_add_u32 m0, s38, 8192
    s_nop 0
    buffer_load_dwordx4 v32, s[12:15], s35 offen lds
    s_add_u32 m0, s38, 9216
    s_nop 0
    buffer_load_dwordx4 v33, s[12:15], s35 offen lds
    s_add_u32 m0, s38, 10240
    s_nop 0
    buffer_load_dwordx4 v34, s[12:15], s35 offen lds
    s_add_u32 m0, s38, 11264
    s_nop 0
    buffer_load_dwordx4 v35, s[12:15], s35 offen lds
    s_add_u32 m0, s38, 16384
    s_nop 0
    buffer_load_dwordx4 v36, s[12:15], s35 offen lds
    s_add_u32 m0, s38, 17408
    s_nop 0
    buffer_load_dwordx4 v37, s[12:15], s35 offen lds
    s_add_u32 m0, s38, 18432
    s_nop 0
    buffer_load_dwordx4 v38, s[12:15], s35 offen lds
    s_add_u32 m0, s38, 19456
    s_nop 0
    buffer_load_dwordx4 v39, s[12:15], s35 offen lds
    s_add_u32 s34, s34, 128
    s_add_u32 s35, s35, 393216
    s_add_u32 s36, s36, 45056
    s_cmp_eq_u32 s36, 135168
    s_cselect_b32 s36, 0, s36
    s_add_u32 s31, s31, 1
    s_cmp_lt_u32 s31, 16
    s_cbranch_scc1 L_lloop
    s_branch L_wo
L_crest:
    s_mul_i32 s30, s26, 10240
    v_and_b32 v1, 15, v0
    v_lshrrev_b32 v5, 4, v0
    v_lshrrev_b32 v3, 1, v1
    v_xor_b32 v3, v3, v5
    v_lshlrev_b32 v3, 4, v3
    v_lshlrev_b32 v1, 7, v1
    v_add_u32 v1, v1, v3
    v_add_u32 v4, s30, v1
    v_xor_b32 v5, 64, v4
    v_add_u32 v8, 90112, v4
    v_add_u32 v9, 90112, v5
    v_lshrrev_b32 v1, 4, v0
    v_lshlrev_b32 v1, 10, v1
    v_bfe_u32 v6, v0, 2, 2
    v_lshlrev_b32 v3, 7, v6
    v_add_u32 v1, v1, v3
    v_lshrrev_b32 v6, 1, v6
    v_xor_b32 v6, s27, v6
    v_lshlrev_b32 v6, 1, v6
    v_bfe_u32 v3, v0, 4, 1
    v_or_b32 v6, v6, v3
    v_lshlrev_b32 v6, 5, v6
    v_add_u32 v1, v1, v6
    v_and_b32 v6, 3, v0
    v_lshlrev_b32 v6, 3, v6
    v_add_u32 v10, v1, v6
    v_add_u32 v12, 110592, v10
    v_add_u32 v11, 65536, v10
    v_add_u32 v10, 20480, v10
    v_xor_b32 v15, 32, v12
    v_xor_b32 v14, 32, v11
    v_xor_b32 v13, 32, v10
    v_mov_b32 v48, 0
    v_mov_b32 v49, 0
    v_mov_b32 v50, 0
    v_mov_b32 v51, 0
    v_mov_b32 v52, 0
    v_mov_b32 v53, 0
    v_mov_b32 v54, 0
    v_mov_b32 v47, 0x3f803f80
    s_cmp_eq_u32 s57, 1
    s_cbranch_scc1 LX2a
    s_waitcnt vmcnt(2)
    s_branch LX2b
LX2a:
    s_waitcnt vmcnt(18)
LX2b:
    v_dot2_f32_bf16 v48, v64, v47, v48
    v_dot2_f32_bf16 v49, v72, v47, v49
    v_dot2_f32_bf16 v50, v64, v64, v50
    v_dot2_f32_bf16 v51, v72, v72, v51
    v_dot2_f32_bf16 v48, v65, v47, v48
    v_dot2_f32_bf16 v49, v73, v47, v49
    v_dot2_f32_bf16 v50, v65, v65, v50
    v_dot2_f32_bf16 v51, v73, v73, v51
    v_dot2_f32_bf16 v48, v66, v47, v48
    v_dot2_f32_bf16 v49, v74, v47, v49
    v_dot2_f32_bf16 v50, v66, v66, v50
    v_dot2_f32_bf16 v51, v74, v74, v51
    v_dot2_f32_bf16 v48, v67, v47, v48
    v_dot2_f32_bf16 v49, v75, v47, v49
    v_dot2_f32_bf16 v50, v67, v67, v50
    v_dot2_f32_bf16 v51, v75, v75, v51
    v_dot2_f32_bf16 v48, v68, v47, v48
    v_dot2_f32_bf16 v49, v76, v47, v49
    v_dot2_f32_bf16 v50, v68, v68, v50
    v_dot2_f32_bf16 v51, v76, v76, v51
    v_dot2_f32_bf16 v48, v69, v47, v48
    v_dot2_f32_bf16 v49, v77, v47, v49
    v_dot2_f32_bf16 v50, v69, v69, v50
    v_dot2_f32_bf16 v51, v77, v77, v51
    v_dot2_f32_bf16 v48, v70, v47, v48
    v_dot2_f32_bf16 v49, v78, v47, v49
    v_dot2_f32_bf16 v50, v70, v70, v50
    v_dot2_f32_bf16 v51, v78, v78, v51
    v_dot2_f32_bf16 v48, v71, v47, v48
    v_dot2_f32_bf16 v49, v79, v47, v49
    v_dot2_f32_bf16 v50, v71, v71, v50
    v_dot2_f32_bf16 v51, v79, v79, v51
    s_cmp_eq_u32 s57, 1
    s_cbranch_scc1 LX0a
    s_waitcnt vmcnt(0)
    s_branch LX0b
LX0a:
    s_waitcnt vmcnt(16)
LX0b:
    v_dot2_f32_bf16 v52, v64, v112, v52
    v_dot2_f32_bf16 v53, v72, v112, v53
    v_dot2_f32_bf16 v54, v112, v47, v54
    v_dot2_f32_bf16 v52, v65, v113, v52
    v_dot2_f32_bf16 v53, v73, v113, v53
    v_dot2_f32_bf16 v54, v113, v47, v54
    v_dot2_f32_bf16 v52, v66, v114, v52
    v_dot2_f32_bf16 v53, v74, v114, v53
    v_dot2_f32_bf16 v54, v114, v47, v54
    v_dot2_f32_bf16 v52, v67, v115, v52
    v_dot2_f32_bf16 v53, v75, v115, v53
    v_dot2_f32_bf16 v54, v115, v47, v54
    v_dot2_f32_bf16 v52, v68, v116, v52
    v_dot2_f32_bf16 v53, v76, v116, v53
    v_dot2_f32_bf16 v54, v116, v47, v54
    v_dot2_f32_bf16 v52, v69, v117, v52
    v_dot2_f32_bf16 v53, v77, v117, v53
    v_dot2_f32_bf16 v54, v117, v47, v54
    v_dot2_f32_bf16 v52, v70, v118, v52
    v_dot2_f32_bf16 v53, v78, v118, v53
    v_dot2_f32_bf16 v54, v118, v47, v54
    v_dot2_f32_bf16 v52, v71, v119, v52
    v_dot2_f32_bf16 v53, v79, v119, v53
    v_dot2_f32_bf16 v54, v119, v47, v54
    s_nop 1
    s_nop 1
    v_add_f32_dpp v48, v48, v48 quad_perm:[1,0,3,2] row_mask:0xf bank_mask:0xf
    v_add_f32_dpp v49, v49, v49 quad_perm:[1,0,3,2] row_mask:0xf bank_mask:0xf
    v_add_f32_dpp v50, v50, v50 quad_perm:[1,0,3,2] row_mask:0xf bank_mask:0xf
    v_add_f32_dpp v51, v51, v51 quad_perm:[1,0,3,2] row_mask:0xf bank_mask:0xf
    v_add_f32_dpp v52, v52, v52 quad_perm:[1,0,3,2] row_mask:0xf bank_mask:0xf
    v_add_f32_dpp v53, v53, v53 quad_perm:[1,0,3,2] row_mask:0xf bank_mask:0xf
    v_add_f32_dpp v54, v54, v54 quad_perm:[1,0,3,2] row_mask:0xf bank_mask:0xf
    v_add_f32_dpp v48, v48, v48 quad_perm:[2,3,0,1] row_mask:0xf bank_mask:0xf
    v_add_f32_dpp v49, v49, v49 quad_perm:[2,3,0,1] row_mask:0xf bank_mask:0xf
    v_add_f32_dpp v50, v50, v50 quad_perm:[2,3,0,1] row_mask:0xf bank_mask:0xf
    v_add_f32_dpp v51, v51, v51 quad_perm:[2,3,0,1] row_mask:0xf bank_mask:0xf
    v_add_f32_dpp v52, v52, v52 quad_perm:[2,3,0,1] row_mask:0xf bank_mask:0xf
    v_add_f32_dpp v53, v53, v53 quad_perm:[2,3,0,1] row_mask:0xf bank_mask:0xf
    v_add_f32_dpp v54, v54, v54 quad_perm:[2,3,0,1] row_mask:0xf bank_mask:0xf
    v_add_f32_dpp v48, v48, v48 row_half_mirror row_mask:0xf bank_mask:0xf
    v_add_f32_dpp v49, v49, v49 row_half_mirror row_mask:0xf bank_mask:0xf
    v_add_f32_dpp v50, v50, v50 row_half_mirror row_mask:0xf bank_mask:0xf
    v_add_f32_dpp v51, v51, v51 row_half_mirror row_mask:0xf bank_mask:0xf
    v_add_f32_dpp v52, v52, v52 row_half_mirror row_mask:0xf bank_mask:0xf
    v_add_f32_dpp v53, v53, v53 row_half_mirror row_mask:0xf bank_mask:0xf
    v_add_f32_dpp v54, v54, v54 row_half_mirror row_mask:0xf bank_mask:0xf
    v_add_f32_dpp v48, v48, v48 row_mirror row_mask:0xf bank_mask:0xf
    v_add_f32_dpp v49, v49, v49 row_mirror row_mask:0xf bank_mask:0xf
    v_add_f32_dpp v50, v50, v50 row_mirror row_mask:0xf bank_mask:0xf
    v_add_f32_dpp v51, v51, v51 row_mirror row_mask:0xf bank_mask:0xf
    v_add_f32_dpp v52, v52, v52 row_mirror row_mask:0xf bank_mask:0xf
    v_add_f32_dpp v53, v53, v53 row_mirror row_mask:0xf bank_mask:0xf
    v_add_f32_dpp v54, v54, v54 row_mirror row_mask:0xf bank_mask:0xf
    v_mov_b32 v16, v48
    v_mov_b32 v17, v49
    v_mov_b32 v18, v50
    v_mov_b32 v19, v51
    v_mov_b32 v20, v52
    v_mov_b32 v21, v53
    v_mov_b32 v22, v54
    v_permlane16_swap_b32 v48, v16
    v_permlane16_swap_b32 v49, v17
    v_permlane16_swap_b32 v50, v18
    v_permlane16_swap_b32 v51, v19
    v_permlane16_swap_b32 v52, v20
    v_permlane16_swap_b32 v53, v21
    v_permlane16_swap_b32 v54, v22
    s_nop 0
    v_add_f32 v48, v48, v16
    v_add_f32 v49, v49, v17
    v_add_f32 v50, v50, v18
    v_add_f32 v51, v51, v19
    v_add_f32 v52, v52, v20
    v_add_f32 v53, v53, v21
    v_add_f32 v54, v54, v22
    v_mov_b32 v16, v48
    v_mov_b32 v17, v49
    v_mov_b32 v18, v50
    v_mov_b32 v19, v51
    v_mov_b32 v20, v52
    v_mov_b32 v21, v53
    v_mov_b32 v22, v54
    v_permlane32_swap_b32 v48, v16
    v_permlane32_swap_b32 v49, v17
    v_permlane32_swap_b32 v50, v18
    v_permlane32_swap_b32 v51, v19
    v_permlane32_swap_b32 v52, v20
    v_permlane32_swap_b32 v53, v21
    v_permlane32_swap_b32 v54, v22
    s_nop 0
    v_add_f32 v48, v48, v16
    v_add_f32 v49, v49, v17
    v_add_f32 v50, v50, v18
    v_add_f32 v51, v51, v19
    v_add_f32 v52, v52, v20
    v_add_f32 v53, v53, v21
    v_add_f32 v54, v54, v22
    v_cmp_eq_u32 vcc, 1, v0
    v_mov_b32 v59, 0
    s_nop 0
    v_cndmask_b32 v56, v48, v49, vcc
    v_cndmask_b32 v57, v50, v51, vcc
    v_cndmask_b32 v58, v52, v53, vcc
    v_mul_f32 v56, 0xba800000, v56
    v_mul_f32 v57, 0x3a800000, v57
    v_fma_f32 v57, -v56, v56, v57
    v_max_f32 v57, 0, v57
    v_cvt_pk_bf16_f32 v56, v56, v56
    v_and_b32 v56, 0xffff0000, v56
    v_cvt_pk_bf16_f32 v57, v57, v57
    v_and_b32 v57, 0xffff0000, v57
    v_add_f32 v57, 0x3727c5ac, v57
    v_cvt_pk_bf16_f32 v57, v57, v57
    v_and_b32 v57, 0xffff0000, v57
    v_sqrt_f32 v57, v57
    s_nop 0
    v_cvt_pk_bf16_f32 v57, v57, v57
    v_and_b32 v57, 0xffff0000, v57
    v_rcp_f32 v57, v57
    v_fmac_f32 v58, v56, v54
    v_mul_f32 v58, v58, v57
    s_lshl_b32 s30, s33, 4
    s_add_u32 s30, s30, 0x510000
    v_ashrrev_i32 v60, 31, v58
    v_or_b32 v60, 0x80000000, v60
    v_xor_b32 v60, v60, v58
    v_and_b32 v60, 0xfffff800, v60
    s_sub_u32 s31, 2047, s33
    v_sub_u32 v61, s31, v0
    v_or_b32 v60, v60, v61
    s_lshl_b32 s31, s25, 3
    s_add_u32 s31, s31, 137216
    v_lshlrev_b32 v61, 2, v0
    v_add_u32 v61, s31, v61
    s_mov_b64 exec, 3
    buffer_store_dwordx4 v[56:59], v2, s[16:19], s30 offen sc1
    ds_write_b32 v61, v60
    s_mov_b64 exec, -1
    s_cmp_eq_u32 s57, 1
    s_cbranch_scc1 L_moe_a
    v_lshrrev_b32 v1, 4, v0
    v_lshlrev_b32 v1, 4, v1
    s_mul_i32 s30, s26, 320
    s_add_u32 s30, s30, 135168
    v_add_u32 v3, s30, v1
    s_lshl_b32 s31, s27, 7
    s_add_u32 s31, s31, 136448
    v_add_u32 v7, s31, v1
    v_and_b32 v1, 15, v0
    v_lshlrev_b32 v1, 2, v1
    v_add_u32 v6, s30, v1
    v_add_u32 v1, s31, v1
    s_mov_b32 s34, 0x3f317218
    s_mov_b32 s35, 0x35c1a2a0
    s_mov_b32 s36, 0x358637bd
    s_lshl_b32 s37, s22, 1
    s_add_u32 s37, s37, s26
    s_cmp_eq_u32 s37, 25
    s_cselect_b32 s59, 0, -1
    v_mov_b32 v252, 0x3f803f80
    v_mov_b32 v253, 0x3f803f80
    v_mov_b32 v254, 0x3f803f80
    v_mov_b32 v255, 0x3f803f80
    s_mov_b64 exec, 0
    s_cmp_lg_u32 s25, 0
    s_cbranch_scc1 L_1
    s_call_b64 s[62:63], L_d4
L_1:
    s_cmp_lg_u32 s25, 1
    s_cbranch_scc1 L_2
L_2:
    s_cmp_lg_u32 s25, 2
    s_cbranch_scc1 L_3
L_3:
    s_cmp_lg_u32 s25, 3
    s_cbranch_scc1 L_4
L_4:
    s_mov_b64 exec, -1
    s_waitcnt lgkmcnt(0)
    s_barrier
    ds_read_b128 v[136:139], v4 offset:0
    ds_read_b64_tr_b16 v[156:157], v10 offset:0
    ds_read_b64_tr_b16 v[158:159], v10 offset:512
    ds_read_b128 v[140:143], v4 offset:2048
    ds_read_b128 v[144:147], v4 offset:4096
    ds_read_b64_tr_b16 v[160:161], v13 offset:0
    ds_read_b64_tr_b16 v[162:163], v13 offset:512
    ds_read_b128 v[148:151], v4 offset:6144
    ds_read_b128 v[152:155], v4 offset:8192
    ds_read_b64_tr_b16 v[164:165], v10 offset:8192
    ds_read_b64_tr_b16 v[166:167], v10 offset:8704
    ds_read_b64_tr_b16 v[168:169], v13 offset:8192
    ds_read_b64_tr_b16 v[170:171], v13 offset:8704
    ds_read_b64_tr_b16 v[172:173], v10 offset:16384
    ds_read_b64_tr_b16 v[174:175], v10 offset:16896
    ds_read_b64_tr_b16 v[176:177], v13 offset:16384
    ds_read_b64_tr_b16 v[178:179], v13 offset:16896
    s_waitcnt lgkmcnt(0)
    v_mfma_f32_16x16x32_bf16 v[16:19], v[156:159], v[136:139], 0
    ds_read_b128 v[180:183], v5 offset:0
    v_mfma_f32_16x16x32_bf16 v[20:23], v[156:159], v[140:143], 0
    ds_read_b64_tr_b16 v[200:201], v10 offset:4096
    v_mfma_f32_16x16x32_bf16 v[24:27], v[156:159], v[144:147], 0
    ds_read_b64_tr_b16 v[202:203], v10 offset:4608
    v_mfma_f32_16x16x32_bf16 v[28:31], v[156:159], v[148:151], 0
    ds_read_b128 v[184:187], v5 offset:2048
    v_mfma_f32_16x16x32_bf16 v[32:35], v[156:159], v[152:155], 0
    ds_read_b128 v[188:191], v5 offset:4096
    v_mfma_f32_16x16x32_bf16 v[52:55], v[160:163], v[152:155], 0
    ds_read_b64_tr_b16 v[204:205], v13 offset:4096
    v_mfma_f32_16x16x32_bf16 v[48:51], v[160:163], v[148:151], 0
    ds_read_b64_tr_b16 v[206:207], v13 offset:4608
    v_mfma_f32_16x16x32_bf16 v[44:47], v[160:163], v[144:147], 0
    ds_read_b128 v[192:195], v5 offset:6144
    v_mfma_f32_16x16x32_bf16 v[40:43], v[160:163], v[140:143], 0
    ds_read_b128 v[196:199], v5 offset:8192
    v_mfma_f32_16x16x32_bf16 v[36:39], v[160:163], v[136:139], 0
    ds_read_b64_tr_b16 v[208:209], v10 offset:12288
    v_mfma_f32_16x16x32_bf16 v[56:59], v[136:139], v[164:167], 0
    ds_read_b64_tr_b16 v[210:211], v10 offset:12800
    v_mfma_f32_16x16x32_bf16 v[60:63], v[140:143], v[164:167], 0
    ds_read_b64_tr_b16 v[212:213], v13 offset:12288
    v_mfma_f32_16x16x32_bf16 v[64:67], v[144:147], v[164:167], 0
    ds_read_b64_tr_b16 v[214:215], v13 offset:12800
    v_mfma_f32_16x16x32_bf16 v[68:71], v[148:151], v[164:167], 0
    ds_read_b64_tr_b16 v[216:217], v10 offset:20480
    v_mfma_f32_16x16x32_bf16 v[72:75], v[152:155], v[164:167], 0
    ds_read_b64_tr_b16 v[218:219], v10 offset:20992
    v_mfma_f32_16x16x32_bf16 v[92:95], v[152:155], v[168:171], 0
    ds_read_b64_tr_b16 v[220:221], v13 offset:20480
    v_mfma_f32_16x16x32_bf16 v[88:91], v[148:151], v[168:171], 0
    ds_read_b64_tr_b16 v[222:223], v13 offset:20992
    v_mfma_f32_16x16x32_bf16 v[84:87], v[144:147], v[168:171], 0
    v_mfma_f32_16x16x32_bf16 v[80:83], v[140:143], v[168:171], 0
    v_mfma_f32_16x16x32_bf16 v[76:79], v[136:139], v[168:171], 0
    v_mfma_f32_16x16x32_bf16 v[96:99], v[136:139], v[172:175], 0
    v_mfma_f32_16x16x32_bf16 v[100:103], v[140:143], v[172:175], 0
    v_mfma_f32_16x16x32_bf16 v[104:107], v[144:147], v[172:175], 0
    v_mfma_f32_16x16x32_bf16 v[108:111], v[148:151], v[172:175], 0
    v_mfma_f32_16x16x32_bf16 v[112:115], v[152:155], v[172:175], 0
    v_mfma_f32_16x16x32_bf16 v[132:135], v[152:155], v[176:179], 0
    v_mfma_f32_16x16x32_bf16 v[128:131], v[148:151], v[176:179], 0
    v_mfma_f32_16x16x32_bf16 v[124:127], v[144:147], v[176:179], 0
    v_mfma_f32_16x16x32_bf16 v[120:123], v[140:143], v[176:179], 0
    v_mfma_f32_16x16x32_bf16 v[116:119], v[136:139], v[176:179], 0
    s_waitcnt vmcnt(0) lgkmcnt(0)
    s_barrier
    v_mfma_f32_16x16x32_bf16 v[16:19], v[200:203], v[180:183], v[16:19]
    ds_read_b128 v[136:139], v4 offset:45056
    v_mfma_f32_16x16x32_bf16 v[20:23], v[200:203], v[184:187], v[20:23]
    ds_read_b64_tr_b16 v[156:157], v11 offset:0
    v_mfma_f32_16x16x32_bf16 v[24:27], v[200:203], v[188:191], v[24:27]
    ds_read_b64_tr_b16 v[158:159], v11 offset:512
    v_mfma_f32_16x16x32_bf16 v[28:31], v[200:203], v[192:195], v[28:31]
    ds_read_b128 v[140:143], v4 offset:47104
    v_mfma_f32_16x16x32_bf16 v[32:35], v[200:203], v[196:199], v[32:35]
    ds_read_b128 v[144:147], v4 offset:49152
    v_mfma_f32_16x16x32_bf16 v[52:55], v[204:207], v[196:199], v[52:55]
    ds_read_b64_tr_b16 v[160:161], v14 offset:0
    v_mfma_f32_16x16x32_bf16 v[48:51], v[204:207], v[192:195], v[48:51]
    ds_read_b64_tr_b16 v[162:163], v14 offset:512
    v_mfma_f32_16x16x32_bf16 v[44:47], v[204:207], v[188:191], v[44:47]
    ds_read_b128 v[148:151], v4 offset:51200
    v_mfma_f32_16x16x32_bf16 v[40:43], v[204:207], v[184:187], v[40:43]
    ds_read_b128 v[152:155], v4 offset:53248
    v_mfma_f32_16x16x32_bf16 v[36:39], v[204:207], v[180:183], v[36:39]
    ds_read_b64_tr_b16 v[164:165], v11 offset:8192
    v_mfma_f32_16x16x32_bf16 v[56:59], v[180:183], v[208:211], v[56:59]
    ds_read_b64_tr_b16 v[166:167], v11 offset:8704
    v_mfma_f32_16x16x32_bf16 v[60:63], v[184:187], v[208:211], v[60:63]
    ds_read_b64_tr_b16 v[168:169], v14 offset:8192
    v_mfma_f32_16x16x32_bf16 v[64:67], v[188:191], v[208:211], v[64:67]
    ds_read_b64_tr_b16 v[170:171], v14 offset:8704
    v_mfma_f32_16x16x32_bf16 v[68:71], v[192:195], v[208:211], v[68:71]
    ds_read_b64_tr_b16 v[172:173], v11 offset:16384
    v_mfma_f32_16x16x32_bf16 v[72:75], v[196:199], v[208:211], v[72:75]
    ds_read_b64_tr_b16 v[174:175], v11 offset:16896
    v_mfma_f32_16x16x32_bf16 v[92:95], v[196:199], v[212:215], v[92:95]
    ds_read_b64_tr_b16 v[176:177], v14 offset:16384
    v_mfma_f32_16x16x32_bf16 v[88:91], v[192:195], v[212:215], v[88:91]
    ds_read_b64_tr_b16 v[178:179], v14 offset:16896
    v_mfma_f32_16x16x32_bf16 v[84:87], v[188:191], v[212:215], v[84:87]
    v_mfma_f32_16x16x32_bf16 v[80:83], v[184:187], v[212:215], v[80:83]
    v_mfma_f32_16x16x32_bf16 v[76:79], v[180:183], v[212:215], v[76:79]
    v_mfma_f32_16x16x32_bf16 v[96:99], v[180:183], v[216:219], v[96:99]
    v_mfma_f32_16x16x32_bf16 v[100:103], v[184:187], v[216:219], v[100:103]
    v_mfma_f32_16x16x32_bf16 v[104:107], v[188:191], v[216:219], v[104:107]
    v_mfma_f32_16x16x32_bf16 v[108:111], v[192:195], v[216:219], v[108:111]
    v_mfma_f32_16x16x32_bf16 v[112:115], v[196:199], v[216:219], v[112:115]
    v_mfma_f32_16x16x32_bf16 v[132:135], v[196:199], v[220:223], v[132:135]
    v_mfma_f32_16x16x32_bf16 v[128:131], v[192:195], v[220:223], v[128:131]
    v_mfma_f32_16x16x32_bf16 v[124:127], v[188:191], v[220:223], v[124:127]
    v_mfma_f32_16x16x32_bf16 v[120:123], v[184:187], v[220:223], v[120:123]
    v_mfma_f32_16x16x32_bf16 v[116:119], v[180:183], v[220:223], v[116:119]
    s_mov_b32 s31, 0
L_cloop:
    s_waitcnt lgkmcnt(0)
    v_mfma_f32_16x16x32_bf16 v[16:19], v[156:159], v[136:139], v[16:19]
    ds_read_b128 v[180:183], v5 offset:45056
    v_mfma_f32_16x16x32_bf16 v[20:23], v[156:159], v[140:143], v[20:23]
    ds_read_b64_tr_b16 v[200:201], v11 offset:4096
    v_mfma_f32_16x16x32_bf16 v[24:27], v[156:159], v[144:147], v[24:27]
    ds_read_b64_tr_b16 v[202:203], v11 offset:4608
    v_mfma_f32_16x16x32_bf16 v[28:31], v[156:159], v[148:151], v[28:31]
    ds_read_b128 v[184:187], v5 offset:47104
    v_mfma_f32_16x16x32_bf16 v[32:35], v[156:159], v[152:155], v[32:35]
    ds_read_b128 v[188:191], v5 offset:49152
    v_mfma_f32_16x16x32_bf16 v[52:55], v[160:163], v[152:155], v[52:55]
    ds_read_b64_tr_b16 v[204:205], v14 offset:4096
    v_mfma_f32_16x16x32_bf16 v[48:51], v[160:163], v[148:151], v[48:51]
    ds_read_b64_tr_b16 v[206:207], v14 offset:4608
    v_mfma_f32_16x16x32_bf16 v[44:47], v[160:163], v[144:147], v[44:47]
    ds_read_b128 v[192:195], v5 offset:51200
    v_mfma_f32_16x16x32_bf16 v[40:43], v[160:163], v[140:143], v[40:43]
    ds_read_b128 v[196:199], v5 offset:53248
    v_mfma_f32_16x16x32_bf16 v[36:39], v[160:163], v[136:139], v[36:39]
    ds_read_b64_tr_b16 v[208:209], v11 offset:12288
    v_mfma_f32_16x16x32_bf16 v[56:59], v[136:139], v[164:167], v[56:59]
    ds_read_b64_tr_b16 v[210:211], v11 offset:12800
    v_mfma_f32_16x16x32_bf16 v[60:63], v[140:143], v[164:167], v[60:63]
    ds_read_b64_tr_b16 v[212:213], v14 offset:12288
    v_mfma_f32_16x16x32_bf16 v[64:67], v[144:147], v[164:167], v[64:67]
    ds_read_b64_tr_b16 v[214:215], v14 offset:12800
    v_mfma_f32_16x16x32_bf16 v[68:71], v[148:151], v[164:167], v[68:71]
    ds_read_b64_tr_b16 v[216:217], v11 offset:20480
    v_mfma_f32_16x16x32_bf16 v[72:75], v[152:155], v[164:167], v[72:75]
    ds_read_b64_tr_b16 v[218:219], v11 offset:20992
    v_mfma_f32_16x16x32_bf16 v[92:95], v[152:155], v[168:171], v[92:95]
    ds_read_b64_tr_b16 v[220:221], v14 offset:20480
    v_mfma_f32_16x16x32_bf16 v[88:91], v[148:151], v[168:171], v[88:91]
    ds_read_b64_tr_b16 v[222:223], v14 offset:20992
    v_mfma_f32_16x16x32_bf16 v[84:87], v[144:147], v[168:171], v[84:87]
    v_mfma_f32_16x16x32_bf16 v[80:83], v[140:143], v[168:171], v[80:83]
    v_mfma_f32_16x16x32_bf16 v[76:79], v[136:139], v[168:171], v[76:79]
    v_mfma_f32_16x16x32_bf16 v[96:99], v[136:139], v[172:175], v[96:99]
    v_mfma_f32_16x16x32_bf16 v[100:103], v[140:143], v[172:175], v[100:103]
    v_mfma_f32_16x16x32_bf16 v[104:107], v[144:147], v[172:175], v[104:107]
    v_mfma_f32_16x16x32_bf16 v[108:111], v[148:151], v[172:175], v[108:111]
    v_mfma_f32_16x16x32_bf16 v[112:115], v[152:155], v[172:175], v[112:115]
    v_mfma_f32_16x16x32_bf16 v[132:135], v[152:155], v[176:179], v[132:135]
    v_mfma_f32_16x16x32_bf16 v[128:131], v[148:151], v[176:179], v[128:131]
    v_mfma_f32_16x16x32_bf16 v[124:127], v[144:147], v[176:179], v[124:127]
    v_mfma_f32_16x16x32_bf16 v[120:123], v[140:143], v[176:179], v[120:123]
    v_mfma_f32_16x16x32_bf16 v[116:119], v[136:139], v[176:179], v[116:119]
    s_waitcnt lgkmcnt(0)
    s_barrier
    v_mfma_f32_16x16x32_bf16 v[16:19], v[200:203], v[180:183], v[16:19]
    ds_read_b128 v[136:139], v8 offset:0
    v_mfma_f32_16x16x32_bf16 v[20:23], v[200:203], v[184:187], v[20:23]
    ds_read_b64_tr_b16 v[156:157], v12 offset:0
    v_mfma_f32_16x16x32_bf16 v[24:27], v[200:203], v[188:191], v[24:27]
    ds_read_b64_tr_b16 v[158:159], v12 offset:512
    v_mfma_f32_16x16x32_bf16 v[28:31], v[200:203], v[192:195], v[28:31]
    ds_read_b128 v[140:143], v8 offset:2048
    v_mfma_f32_16x16x32_bf16 v[32:35], v[200:203], v[196:199], v[32:35]
    ds_read_b128 v[144:147], v8 offset:4096
    v_mfma_f32_16x16x32_bf16 v[52:55], v[204:207], v[196:199], v[52:55]
    ds_read_b64_tr_b16 v[160:161], v15 offset:0
    v_mfma_f32_16x16x32_bf16 v[48:51], v[204:207], v[192:195], v[48:51]
    ds_read_b64_tr_b16 v[162:163], v15 offset:512
    v_mfma_f32_16x16x32_bf16 v[44:47], v[204:207], v[188:191], v[44:47]
    ds_read_b128 v[148:151], v8 offset:6144
    v_mfma_f32_16x16x32_bf16 v[40:43], v[204:207], v[184:187], v[40:43]
    ds_read_b128 v[152:155], v8 offset:8192
    v_mfma_f32_16x16x32_bf16 v[36:39], v[204:207], v[180:183], v[36:39]
    ds_read_b64_tr_b16 v[164:165], v12 offset:8192
    v_mfma_f32_16x16x32_bf16 v[56:59], v[180:183], v[208:211], v[56:59]
    ds_read_b64_tr_b16 v[166:167], v12 offset:8704
    v_mfma_f32_16x16x32_bf16 v[60:63], v[184:187], v[208:211], v[60:63]
    ds_read_b64_tr_b16 v[168:169], v15 offset:8192
    v_mfma_f32_16x16x32_bf16 v[64:67], v[188:191], v[208:211], v[64:67]
    ds_read_b64_tr_b16 v[170:171], v15 offset:8704
    v_mfma_f32_16x16x32_bf16 v[68:71], v[192:195], v[208:211], v[68:71]
    ds_read_b64_tr_b16 v[172:173], v12 offset:16384
    v_mfma_f32_16x16x32_bf16 v[72:75], v[196:199], v[208:211], v[72:75]
    ds_read_b64_tr_b16 v[174:175], v12 offset:16896
    v_mfma_f32_16x16x32_bf16 v[92:95], v[196:199], v[212:215], v[92:95]
    ds_read_b64_tr_b16 v[176:177], v15 offset:16384
    v_mfma_f32_16x16x32_bf16 v[88:91], v[192:195], v[212:215], v[88:91]
    ds_read_b64_tr_b16 v[178:179], v15 offset:16896
    v_mfma_f32_16x16x32_bf16 v[84:87], v[188:191], v[212:215], v[84:87]
    v_mfma_f32_16x16x32_bf16 v[80:83], v[184:187], v[212:215], v[80:83]
    v_mfma_f32_16x16x32_bf16 v[76:79], v[180:183], v[212:215], v[76:79]
    v_mfma_f32_16x16x32_bf16 v[96:99], v[180:183], v[216:219], v[96:99]
    v_mfma_f32_16x16x32_bf16 v[100:103], v[184:187], v[216:219], v[100:103]
    v_mfma_f32_16x16x32_bf16 v[104:107], v[188:191], v[216:219], v[104:107]
    v_mfma_f32_16x16x32_bf16 v[108:111], v[192:195], v[216:219], v[108:111]
    v_mfma_f32_16x16x32_bf16 v[112:115], v[196:199], v[216:219], v[112:115]
    v_mfma_f32_16x16x32_bf16 v[132:135], v[196:199], v[220:223], v[132:135]
    v_mfma_f32_16x16x32_bf16 v[128:131], v[192:195], v[220:223], v[128:131]
    v_mfma_f32_16x16x32_bf16 v[124:127], v[188:191], v[220:223], v[124:127]
    v_mfma_f32_16x16x32_bf16 v[120:123], v[184:187], v[220:223], v[120:123]
    v_mfma_f32_16x16x32_bf16 v[116:119], v[180:183], v[220:223], v[116:119]
    s_waitcnt lgkmcnt(0)
    v_mfma_f32_16x16x32_bf16 v[16:19], v[156:159], v[136:139], v[16:19]
    ds_read_b128 v[180:183], v9 offset:0
    v_mfma_f32_16x16x32_bf16 v[20:23], v[156:159], v[140:143], v[20:23]
    ds_read_b64_tr_b16 v[200:201], v12 offset:4096
    v_mfma_f32_16x16x32_bf16 v[24:27], v[156:159], v[144:147], v[24:27]
    ds_read_b64_tr_b16 v[202:203], v12 offset:4608
    v_mfma_f32_16x16x32_bf16 v[28:31], v[156:159], v[148:151], v[28:31]
    ds_read_b128 v[184:187], v9 offset:2048
    v_mfma_f32_16x16x32_bf16 v[32:35], v[156:159], v[152:155], v[32:35]
    ds_read_b128 v[188:191], v9 offset:4096
    v_mfma_f32_16x16x32_bf16 v[52:55], v[160:163], v[152:155], v[52:55]
    ds_read_b64_tr_b16 v[204:205], v15 offset:4096
    v_mfma_f32_16x16x32_bf16 v[48:51], v[160:163], v[148:151], v[48:51]
    ds_read_b64_tr_b16 v[206:207], v15 offset:4608
    v_mfma_f32_16x16x32_bf16 v[44:47], v[160:163], v[144:147], v[44:47]
    ds_read_b128 v[192:195], v9 offset:6144
    v_mfma_f32_16x16x32_bf16 v[40:43], v[160:163], v[140:143], v[40:43]
    ds_read_b128 v[196:199], v9 offset:8192
    v_mfma_f32_16x16x32_bf16 v[36:39], v[160:163], v[136:139], v[36:39]
    ds_read_b64_tr_b16 v[208:209], v12 offset:12288
    v_mfma_f32_16x16x32_bf16 v[56:59], v[136:139], v[164:167], v[56:59]
    ds_read_b64_tr_b16 v[210:211], v12 offset:12800
    v_mfma_f32_16x16x32_bf16 v[60:63], v[140:143], v[164:167], v[60:63]
    ds_read_b64_tr_b16 v[212:213], v15 offset:12288
    v_mfma_f32_16x16x32_bf16 v[64:67], v[144:147], v[164:167], v[64:67]
    ds_read_b64_tr_b16 v[214:215], v15 offset:12800
    v_mfma_f32_16x16x32_bf16 v[68:71], v[148:151], v[164:167], v[68:71]
    ds_read_b64_tr_b16 v[216:217], v12 offset:20480
    v_mfma_f32_16x16x32_bf16 v[72:75], v[152:155], v[164:167], v[72:75]
    ds_read_b64_tr_b16 v[218:219], v12 offset:20992
    v_mfma_f32_16x16x32_bf16 v[92:95], v[152:155], v[168:171], v[92:95]
    ds_read_b64_tr_b16 v[220:221], v15 offset:20480
    v_mfma_f32_16x16x32_bf16 v[88:91], v[148:151], v[168:171], v[88:91]
    ds_read_b64_tr_b16 v[222:223], v15 offset:20992
    v_mfma_f32_16x16x32_bf16 v[84:87], v[144:147], v[168:171], v[84:87]
    v_mfma_f32_16x16x32_bf16 v[80:83], v[140:143], v[168:171], v[80:83]
    v_mfma_f32_16x16x32_bf16 v[76:79], v[136:139], v[168:171], v[76:79]
    v_mfma_f32_16x16x32_bf16 v[96:99], v[136:139], v[172:175], v[96:99]
    v_mfma_f32_16x16x32_bf16 v[100:103], v[140:143], v[172:175], v[100:103]
    v_mfma_f32_16x16x32_bf16 v[104:107], v[144:147], v[172:175], v[104:107]
    v_mfma_f32_16x16x32_bf16 v[108:111], v[148:151], v[172:175], v[108:111]
    v_mfma_f32_16x16x32_bf16 v[112:115], v[152:155], v[172:175], v[112:115]
    v_mfma_f32_16x16x32_bf16 v[132:135], v[152:155], v[176:179], v[132:135]
    v_mfma_f32_16x16x32_bf16 v[128:131], v[148:151], v[176:179], v[128:131]
    v_mfma_f32_16x16x32_bf16 v[124:127], v[144:147], v[176:179], v[124:127]
    v_mfma_f32_16x16x32_bf16 v[120:123], v[140:143], v[176:179], v[120:123]
    v_mfma_f32_16x16x32_bf16 v[116:119], v[136:139], v[176:179], v[116:119]
    s_waitcnt lgkmcnt(0)
    s_barrier
    v_mfma_f32_16x16x32_bf16 v[16:19], v[200:203], v[180:183], v[16:19]
    ds_read_b128 v[136:139], v4 offset:0
    v_mfma_f32_16x16x32_bf16 v[20:23], v[200:203], v[184:187], v[20:23]
    ds_read_b64_tr_b16 v[156:157], v10 offset:0
    v_mfma_f32_16x16x32_bf16 v[24:27], v[200:203], v[188:191], v[24:27]
    ds_read_b64_tr_b16 v[158:159], v10 offset:512
    v_mfma_f32_16x16x32_bf16 v[28:31], v[200:203], v[192:195], v[28:31]
    ds_read_b128 v[140:143], v4 offset:2048
    v_mfma_f32_16x16x32_bf16 v[32:35], v[200:203], v[196:199], v[32:35]
    ds_read_b128 v[144:147], v4 offset:4096
    v_mfma_f32_16x16x32_bf16 v[52:55], v[204:207], v[196:199], v[52:55]
    ds_read_b64_tr_b16 v[160:161], v13 offset:0
    v_mfma_f32_16x16x32_bf16 v[48:51], v[204:207], v[192:195], v[48:51]
    ds_read_b64_tr_b16 v[162:163], v13 offset:512
    v_mfma_f32_16x16x32_bf16 v[44:47], v[204:207], v[188:191], v[44:47]
    ds_read_b128 v[148:151], v4 offset:6144
    v_mfma_f32_16x16x32_bf16 v[40:43], v[204:207], v[184:187], v[40:43]
    ds_read_b128 v[152:155], v4 offset:8192
    v_mfma_f32_16x16x32_bf16 v[36:39], v[204:207], v[180:183], v[36:39]
    ds_read_b64_tr_b16 v[164:165], v10 offset:8192
    v_mfma_f32_16x16x32_bf16 v[56:59], v[180:183], v[208:211], v[56:59]
    ds_read_b64_tr_b16 v[166:167], v10 offset:8704
    v_mfma_f32_16x16x32_bf16 v[60:63], v[184:187], v[208:211], v[60:63]
    ds_read_b64_tr_b16 v[168:169], v13 offset:8192
    v_mfma_f32_16x16x32_bf16 v[64:67], v[188:191], v[208:211], v[64:67]
    ds_read_b64_tr_b16 v[170:171], v13 offset:8704
    v_mfma_f32_16x16x32_bf16 v[68:71], v[192:195], v[208:211], v[68:71]
    ds_read_b64_tr_b16 v[172:173], v10 offset:16384
    v_mfma_f32_16x16x32_bf16 v[72:75], v[196:199], v[208:211], v[72:75]
    ds_read_b64_tr_b16 v[174:175], v10 offset:16896
    v_mfma_f32_16x16x32_bf16 v[92:95], v[196:199], v[212:215], v[92:95]
    ds_read_b64_tr_b16 v[176:177], v13 offset:16384
    v_mfma_f32_16x16x32_bf16 v[88:91], v[192:195], v[212:215], v[88:91]
    ds_read_b64_tr_b16 v[178:179], v13 offset:16896
    v_mfma_f32_16x16x32_bf16 v[84:87], v[188:191], v[212:215], v[84:87]
    v_mfma_f32_16x16x32_bf16 v[80:83], v[184:187], v[212:215], v[80:83]
    v_mfma_f32_16x16x32_bf16 v[76:79], v[180:183], v[212:215], v[76:79]
    v_mfma_f32_16x16x32_bf16 v[96:99], v[180:183], v[216:219], v[96:99]
    v_mfma_f32_16x16x32_bf16 v[100:103], v[184:187], v[216:219], v[100:103]
    v_mfma_f32_16x16x32_bf16 v[104:107], v[188:191], v[216:219], v[104:107]
    v_mfma_f32_16x16x32_bf16 v[108:111], v[192:195], v[216:219], v[108:111]
    v_mfma_f32_16x16x32_bf16 v[112:115], v[196:199], v[216:219], v[112:115]
    v_mfma_f32_16x16x32_bf16 v[132:135], v[196:199], v[220:223], v[132:135]
    v_mfma_f32_16x16x32_bf16 v[128:131], v[192:195], v[220:223], v[128:131]
    v_mfma_f32_16x16x32_bf16 v[124:127], v[188:191], v[220:223], v[124:127]
    v_mfma_f32_16x16x32_bf16 v[120:123], v[184:187], v[220:223], v[120:123]
    v_mfma_f32_16x16x32_bf16 v[116:119], v[180:183], v[220:223], v[116:119]
    s_waitcnt lgkmcnt(0)
    v_mfma_f32_16x16x32_bf16 v[16:19], v[156:159], v[136:139], v[16:19]
    ds_read_b128 v[180:183], v5 offset:0
    v_mfma_f32_16x16x32_bf16 v[20:23], v[156:159], v[140:143], v[20:23]
    ds_read_b64_tr_b16 v[200:201], v10 offset:4096
    v_mfma_f32_16x16x32_bf16 v[24:27], v[156:159], v[144:147], v[24:27]
    ds_read_b64_tr_b16 v[202:203], v10 offset:4608
    v_mfma_f32_16x16x32_bf16 v[28:31], v[156:159], v[148:151], v[28:31]
    ds_read_b128 v[184:187], v5 offset:2048
    v_mfma_f32_16x16x32_bf16 v[32:35], v[156:159], v[152:155], v[32:35]
    ds_read_b128 v[188:191], v5 offset:4096
    v_mfma_f32_16x16x32_bf16 v[52:55], v[160:163], v[152:155], v[52:55]
    ds_read_b64_tr_b16 v[204:205], v13 offset:4096
    v_mfma_f32_16x16x32_bf16 v[48:51], v[160:163], v[148:151], v[48:51]
    ds_read_b64_tr_b16 v[206:207], v13 offset:4608
    v_mfma_f32_16x16x32_bf16 v[44:47], v[160:163], v[144:147], v[44:47]
    ds_read_b128 v[192:195], v5 offset:6144
    v_mfma_f32_16x16x32_bf16 v[40:43], v[160:163], v[140:143], v[40:43]
    ds_read_b128 v[196:199], v5 offset:8192
    v_mfma_f32_16x16x32_bf16 v[36:39], v[160:163], v[136:139], v[36:39]
    ds_read_b64_tr_b16 v[208:209], v10 offset:12288
    v_mfma_f32_16x16x32_bf16 v[56:59], v[136:139], v[164:167], v[56:59]
    ds_read_b64_tr_b16 v[210:211], v10 offset:12800
    v_mfma_f32_16x16x32_bf16 v[60:63], v[140:143], v[164:167], v[60:63]
    ds_read_b64_tr_b16 v[212:213], v13 offset:12288
    v_mfma_f32_16x16x32_bf16 v[64:67], v[144:147], v[164:167], v[64:67]
    ds_read_b64_tr_b16 v[214:215], v13 offset:12800
    v_mfma_f32_16x16x32_bf16 v[68:71], v[148:151], v[164:167], v[68:71]
    ds_read_b64_tr_b16 v[216:217], v10 offset:20480
    v_mfma_f32_16x16x32_bf16 v[72:75], v[152:155], v[164:167], v[72:75]
    ds_read_b64_tr_b16 v[218:219], v10 offset:20992
    v_mfma_f32_16x16x32_bf16 v[92:95], v[152:155], v[168:171], v[92:95]
    ds_read_b64_tr_b16 v[220:221], v13 offset:20480
    v_mfma_f32_16x16x32_bf16 v[88:91], v[148:151], v[168:171], v[88:91]
    ds_read_b64_tr_b16 v[222:223], v13 offset:20992
    v_mfma_f32_16x16x32_bf16 v[84:87], v[144:147], v[168:171], v[84:87]
    v_mfma_f32_16x16x32_bf16 v[80:83], v[140:143], v[168:171], v[80:83]
    v_mfma_f32_16x16x32_bf16 v[76:79], v[136:139], v[168:171], v[76:79]
    v_mfma_f32_16x16x32_bf16 v[96:99], v[136:139], v[172:175], v[96:99]
    v_mfma_f32_16x16x32_bf16 v[100:103], v[140:143], v[172:175], v[100:103]
    v_mfma_f32_16x16x32_bf16 v[104:107], v[144:147], v[172:175], v[104:107]
    v_mfma_f32_16x16x32_bf16 v[108:111], v[148:151], v[172:175], v[108:111]
    v_mfma_f32_16x16x32_bf16 v[112:115], v[152:155], v[172:175], v[112:115]
    v_mfma_f32_16x16x32_bf16 v[132:135], v[152:155], v[176:179], v[132:135]
    v_mfma_f32_16x16x32_bf16 v[128:131], v[148:151], v[176:179], v[128:131]
    v_mfma_f32_16x16x32_bf16 v[124:127], v[144:147], v[176:179], v[124:127]
    v_mfma_f32_16x16x32_bf16 v[120:123], v[140:143], v[176:179], v[120:123]
    v_mfma_f32_16x16x32_bf16 v[116:119], v[136:139], v[176:179], v[116:119]
    s_waitcnt lgkmcnt(0)
    s_barrier
    v_mfma_f32_16x16x32_bf16 v[16:19], v[200:203], v[180:183], v[16:19]
    ds_read_b128 v[136:139], v4 offset:45056
    v_mfma_f32_16x16x32_bf16 v[20:23], v[200:203], v[184:187], v[20:23]
    ds_read_b64_tr_b16 v[156:157], v11 offset:0
    v_mfma_f32_16x16x32_bf16 v[24:27], v[200:203], v[188:191], v[24:27]
    ds_read_b64_tr_b16 v[158:159], v11 offset:512
    v_mfma_f32_16x16x32_bf16 v[28:31], v[200:203], v[192:195], v[28:31]
    ds_read_b128 v[140:143], v4 offset:47104
    v_mfma_f32_16x16x32_bf16 v[32:35], v[200:203], v[196:199], v[32:35]
    ds_read_b128 v[144:147], v4 offset:49152
    v_mfma_f32_16x16x32_bf16 v[52:55], v[204:207], v[196:199], v[52:55]
    ds_read_b64_tr_b16 v[160:161], v14 offset:0
    v_mfma_f32_16x16x32_bf16 v[48:51], v[204:207], v[192:195], v[48:51]
    ds_read_b64_tr_b16 v[162:163], v14 offset:512
    v_mfma_f32_16x16x32_bf16 v[44:47], v[204:207], v[188:191], v[44:47]
    ds_read_b128 v[148:151], v4 offset:51200
    v_mfma_f32_16x16x32_bf16 v[40:43], v[204:207], v[184:187], v[40:43]
    ds_read_b128 v[152:155], v4 offset:53248
    v_mfma_f32_16x16x32_bf16 v[36:39], v[204:207], v[180:183], v[36:39]
    ds_read_b64_tr_b16 v[164:165], v11 offset:8192
    v_mfma_f32_16x16x32_bf16 v[56:59], v[180:183], v[208:211], v[56:59]
    ds_read_b64_tr_b16 v[166:167], v11 offset:8704
    v_mfma_f32_16x16x32_bf16 v[60:63], v[184:187], v[208:211], v[60:63]
    ds_read_b64_tr_b16 v[168:169], v14 offset:8192
    v_mfma_f32_16x16x32_bf16 v[64:67], v[188:191], v[208:211], v[64:67]
    ds_read_b64_tr_b16 v[170:171], v14 offset:8704
    v_mfma_f32_16x16x32_bf16 v[68:71], v[192:195], v[208:211], v[68:71]
    ds_read_b64_tr_b16 v[172:173], v11 offset:16384
    v_mfma_f32_16x16x32_bf16 v[72:75], v[196:199], v[208:211], v[72:75]
    ds_read_b64_tr_b16 v[174:175], v11 offset:16896
    v_mfma_f32_16x16x32_bf16 v[92:95], v[196:199], v[212:215], v[92:95]
    ds_read_b64_tr_b16 v[176:177], v14 offset:16384
    v_mfma_f32_16x16x32_bf16 v[88:91], v[192:195], v[212:215], v[88:91]
    ds_read_b64_tr_b16 v[178:179], v14 offset:16896
    v_mfma_f32_16x16x32_bf16 v[84:87], v[188:191], v[212:215], v[84:87]
    v_mfma_f32_16x16x32_bf16 v[80:83], v[184:187], v[212:215], v[80:83]
    v_mfma_f32_16x16x32_bf16 v[76:79], v[180:183], v[212:215], v[76:79]
    v_mfma_f32_16x16x32_bf16 v[96:99], v[180:183], v[216:219], v[96:99]
    v_mfma_f32_16x16x32_bf16 v[100:103], v[184:187], v[216:219], v[100:103]
    v_mfma_f32_16x16x32_bf16 v[104:107], v[188:191], v[216:219], v[104:107]
    v_mfma_f32_16x16x32_bf16 v[108:111], v[192:195], v[216:219], v[108:111]
    v_mfma_f32_16x16x32_bf16 v[112:115], v[196:199], v[216:219], v[112:115]
    v_mfma_f32_16x16x32_bf16 v[132:135], v[196:199], v[220:223], v[132:135]
    v_mfma_f32_16x16x32_bf16 v[128:131], v[192:195], v[220:223], v[128:131]
    v_mfma_f32_16x16x32_bf16 v[124:127], v[188:191], v[220:223], v[124:127]
    v_mfma_f32_16x16x32_bf16 v[120:123], v[184:187], v[220:223], v[120:123]
    v_mfma_f32_16x16x32_bf16 v[116:119], v[180:183], v[220:223], v[116:119]
    s_add_u32 s31, s31, 1
    s_cmp_lt_u32 s31, 4
    s_cbranch_scc1 L_cloop
    s_waitcnt lgkmcnt(0)
    v_mfma_f32_16x16x32_bf16 v[56:59], v[136:139], v[164:167], v[56:59]
    ds_read_b128 v[180:183], v5 offset:45056
    v_mfma_f32_16x16x32_bf16 v[60:63], v[140:143], v[164:167], v[60:63]
    ds_read_b64_tr_b16 v[208:209], v11 offset:12288
    v_mfma_f32_16x16x32_bf16 v[64:67], v[144:147], v[164:167], v[64:67]
    ds_read_b64_tr_b16 v[210:211], v11 offset:12800
    v_mfma_f32_16x16x32_bf16 v[68:71], v[148:151], v[164:167], v[68:71]
    ds_read_b128 v[184:187], v5 offset:47104
    v_mfma_f32_16x16x32_bf16 v[72:75], v[152:155], v[164:167], v[72:75]
    ds_read_b128 v[188:191], v5 offset:49152
    v_mfma_f32_16x16x32_bf16 v[92:95], v[152:155], v[168:171], v[92:95]
    ds_read_b64_tr_b16 v[212:213], v14 offset:12288
    v_mfma_f32_16x16x32_bf16 v[88:91], v[148:151], v[168:171], v[88:91]
    ds_read_b64_tr_b16 v[214:215], v14 offset:12800
    v_mfma_f32_16x16x32_bf16 v[84:87], v[144:147], v[168:171], v[84:87]
    ds_read_b128 v[192:195], v5 offset:51200
    v_mfma_f32_16x16x32_bf16 v[80:83], v[140:143], v[168:171], v[80:83]
    ds_read_b128 v[196:199], v5 offset:53248
    v_mfma_f32_16x16x32_bf16 v[76:79], v[136:139], v[168:171], v[76:79]
    ds_read_b64_tr_b16 v[216:217], v11 offset:20480
    v_mfma_f32_16x16x32_bf16 v[96:99], v[136:139], v[172:175], v[96:99]
    ds_read_b64_tr_b16 v[218:219], v11 offset:20992
    v_mfma_f32_16x16x32_bf16 v[100:103], v[140:143], v[172:175], v[100:103]
    ds_read_b64_tr_b16 v[220:221], v14 offset:20480
    v_mfma_f32_16x16x32_bf16 v[104:107], v[144:147], v[172:175], v[104:107]
    ds_read_b64_tr_b16 v[222:223], v14 offset:20992
    v_mfma_f32_16x16x32_bf16 v[108:111], v[148:151], v[172:175], v[108:111]
    v_mfma_f32_16x16x32_bf16 v[112:115], v[152:155], v[172:175], v[112:115]
    v_mfma_f32_16x16x32_bf16 v[132:135], v[152:155], v[176:179], v[132:135]
    v_mfma_f32_16x16x32_bf16 v[128:131], v[148:151], v[176:179], v[128:131]
    v_mfma_f32_16x16x32_bf16 v[124:127], v[144:147], v[176:179], v[124:127]
    v_mfma_f32_16x16x32_bf16 v[120:123], v[140:143], v[176:179], v[120:123]
    v_mfma_f32_16x16x32_bf16 v[116:119], v[136:139], v[176:179], v[116:119]
    s_waitcnt lgkmcnt(0)
    s_barrier
    v_mfma_f32_16x16x32_bf16 v[56:59], v[180:183], v[208:211], v[56:59]
    ds_read_b128 v[136:139], v8 offset:0
    v_mfma_f32_16x16x32_bf16 v[60:63], v[184:187], v[208:211], v[60:63]
    ds_read_b64_tr_b16 v[164:165], v12 offset:8192
    v_mfma_f32_16x16x32_bf16 v[64:67], v[188:191], v[208:211], v[64:67]
    ds_read_b64_tr_b16 v[166:167], v12 offset:8704
    v_mfma_f32_16x16x32_bf16 v[68:71], v[192:195], v[208:211], v[68:71]
    ds_read_b128 v[140:143], v8 offset:2048
    v_mfma_f32_16x16x32_bf16 v[72:75], v[196:199], v[208:211], v[72:75]
    ds_read_b128 v[144:147], v8 offset:4096
    v_mfma_f32_16x16x32_bf16 v[92:95], v[196:199], v[212:215], v[92:95]
    ds_read_b64_tr_b16 v[168:169], v15 offset:8192
    v_mfma_f32_16x16x32_bf16 v[88:91], v[192:195], v[212:215], v[88:91]
    ds_read_b64_tr_b16 v[170:171], v15 offset:8704
    v_mfma_f32_16x16x32_bf16 v[84:87], v[188:191], v[212:215], v[84:87]
    ds_read_b128 v[148:151], v8 offset:6144
    v_mfma_f32_16x16x32_bf16 v[80:83], v[184:187], v[212:215], v[80:83]
    ds_read_b128 v[152:155], v8 offset:8192
    v_mfma_f32_16x16x32_bf16 v[76:79], v[180:183], v[212:215], v[76:79]
    ds_read_b64_tr_b16 v[172:173], v12 offset:16384
    v_mfma_f32_16x16x32_bf16 v[96:99], v[180:183], v[216:219], v[96:99]
    ds_read_b64_tr_b16 v[174:175], v12 offset:16896
    v_mfma_f32_16x16x32_bf16 v[100:103], v[184:187], v[216:219], v[100:103]
    ds_read_b64_tr_b16 v[176:177], v15 offset:16384
    v_mfma_f32_16x16x32_bf16 v[104:107], v[188:191], v[216:219], v[104:107]
    ds_read_b64_tr_b16 v[178:179], v15 offset:16896
    v_mfma_f32_16x16x32_bf16 v[108:111], v[192:195], v[216:219], v[108:111]
    v_mfma_f32_16x16x32_bf16 v[112:115], v[196:199], v[216:219], v[112:115]
    v_mfma_f32_16x16x32_bf16 v[132:135], v[196:199], v[220:223], v[132:135]
    v_mfma_f32_16x16x32_bf16 v[128:131], v[192:195], v[220:223], v[128:131]
    v_mfma_f32_16x16x32_bf16 v[124:127], v[188:191], v[220:223], v[124:127]
    v_mfma_f32_16x16x32_bf16 v[120:123], v[184:187], v[220:223], v[120:123]
    v_mfma_f32_16x16x32_bf16 v[116:119], v[180:183], v[220:223], v[116:119]
    s_waitcnt lgkmcnt(0)
    v_mfma_f32_16x16x32_bf16 v[56:59], v[136:139], v[164:167], v[56:59]
    ds_read_b128 v[180:183], v9 offset:0
    v_mfma_f32_16x16x32_bf16 v[60:63], v[140:143], v[164:167], v[60:63]
    ds_read_b64_tr_b16 v[208:209], v12 offset:12288
    v_mfma_f32_16x16x32_bf16 v[64:67], v[144:147], v[164:167], v[64:67]
    ds_read_b64_tr_b16 v[210:211], v12 offset:12800
    v_mfma_f32_16x16x32_bf16 v[68:71], v[148:151], v[164:167], v[68:71]
    ds_read_b128 v[184:187], v9 offset:2048
    v_mfma_f32_16x16x32_bf16 v[72:75], v[152:155], v[164:167], v[72:75]
    ds_read_b128 v[188:191], v9 offset:4096
    v_mfma_f32_16x16x32_bf16 v[92:95], v[152:155], v[168:171], v[92:95]
    ds_read_b64_tr_b16 v[212:213], v15 offset:12288
    v_mfma_f32_16x16x32_bf16 v[88:91], v[148:151], v[168:171], v[88:91]
    ds_read_b64_tr_b16 v[214:215], v15 offset:12800
    v_mfma_f32_16x16x32_bf16 v[84:87], v[144:147], v[168:171], v[84:87]
    ds_read_b128 v[192:195], v9 offset:6144
    v_mfma_f32_16x16x32_bf16 v[80:83], v[140:143], v[168:171], v[80:83]
    ds_read_b128 v[196:199], v9 offset:8192
    v_mfma_f32_16x16x32_bf16 v[76:79], v[136:139], v[168:171], v[76:79]
    ds_read_b64_tr_b16 v[216:217], v12 offset:20480
    v_mfma_f32_16x16x32_bf16 v[96:99], v[136:139], v[172:175], v[96:99]
    ds_read_b64_tr_b16 v[218:219], v12 offset:20992
    v_mfma_f32_16x16x32_bf16 v[100:103], v[140:143], v[172:175], v[100:103]
    ds_read_b64_tr_b16 v[220:221], v15 offset:20480
    v_mfma_f32_16x16x32_bf16 v[104:107], v[144:147], v[172:175], v[104:107]
    ds_read_b64_tr_b16 v[222:223], v15 offset:20992
    v_mfma_f32_16x16x32_bf16 v[108:111], v[148:151], v[172:175], v[108:111]
    v_mfma_f32_16x16x32_bf16 v[112:115], v[152:155], v[172:175], v[112:115]
    v_mfma_f32_16x16x32_bf16 v[132:135], v[152:155], v[176:179], v[132:135]
    v_mfma_f32_16x16x32_bf16 v[128:131], v[148:151], v[176:179], v[128:131]
    v_mfma_f32_16x16x32_bf16 v[124:127], v[144:147], v[176:179], v[124:127]
    v_mfma_f32_16x16x32_bf16 v[120:123], v[140:143], v[176:179], v[120:123]
    v_mfma_f32_16x16x32_bf16 v[116:119], v[136:139], v[176:179], v[116:119]
    s_waitcnt lgkmcnt(0)
    s_barrier
    v_mfma_f32_16x16x32_bf16 v[56:59], v[180:183], v[208:211], v[56:59]
    ds_read_b128 v[136:139], v4 offset:0
    v_mfma_f32_16x16x32_bf16 v[60:63], v[184:187], v[208:211], v[60:63]
    ds_read_b64_tr_b16 v[164:165], v10 offset:8192
    v_mfma_f32_16x16x32_bf16 v[64:67], v[188:191], v[208:211], v[64:67]
    ds_read_b64_tr_b16 v[166:167], v10 offset:8704
    v_mfma_f32_16x16x32_bf16 v[68:71], v[192:195], v[208:211], v[68:71]
    ds_read_b128 v[140:143], v4 offset:2048
    v_mfma_f32_16x16x32_bf16 v[72:75], v[196:199], v[208:211], v[72:75]
    ds_read_b128 v[144:147], v4 offset:4096
    v_mfma_f32_16x16x32_bf16 v[92:95], v[196:199], v[212:215], v[92:95]
    ds_read_b64_tr_b16 v[168:169], v13 offset:8192
    v_mfma_f32_16x16x32_bf16 v[88:91], v[192:195], v[212:215], v[88:91]
    ds_read_b64_tr_b16 v[170:171], v13 offset:8704
    v_mfma_f32_16x16x32_bf16 v[84:87], v[188:191], v[212:215], v[84:87]
    ds_read_b128 v[148:151], v4 offset:6144
    v_mfma_f32_16x16x32_bf16 v[80:83], v[184:187], v[212:215], v[80:83]
    ds_read_b128 v[152:155], v4 offset:8192
    v_mfma_f32_16x16x32_bf16 v[76:79], v[180:183], v[212:215], v[76:79]
    ds_read_b64_tr_b16 v[172:173], v10 offset:16384
    v_mfma_f32_16x16x32_bf16 v[96:99], v[180:183], v[216:219], v[96:99]
    ds_read_b64_tr_b16 v[174:175], v10 offset:16896
    v_mfma_f32_16x16x32_bf16 v[100:103], v[184:187], v[216:219], v[100:103]
    ds_read_b64_tr_b16 v[176:177], v13 offset:16384
    v_mfma_f32_16x16x32_bf16 v[104:107], v[188:191], v[216:219], v[104:107]
    ds_read_b64_tr_b16 v[178:179], v13 offset:16896
    v_mfma_f32_16x16x32_bf16 v[108:111], v[192:195], v[216:219], v[108:111]
    v_mfma_f32_16x16x32_bf16 v[112:115], v[196:199], v[216:219], v[112:115]
    v_mfma_f32_16x16x32_bf16 v[132:135], v[196:199], v[220:223], v[132:135]
    v_mfma_f32_16x16x32_bf16 v[128:131], v[192:195], v[220:223], v[128:131]
    v_mfma_f32_16x16x32_bf16 v[124:127], v[188:191], v[220:223], v[124:127]
    v_mfma_f32_16x16x32_bf16 v[120:123], v[184:187], v[220:223], v[120:123]
    v_mfma_f32_16x16x32_bf16 v[116:119], v[180:183], v[220:223], v[116:119]
    s_waitcnt lgkmcnt(0)
    v_mfma_f32_16x16x32_bf16 v[56:59], v[136:139], v[164:167], v[56:59]
    ds_read_b128 v[180:183], v5 offset:0
    v_mfma_f32_16x16x32_bf16 v[60:63], v[140:143], v[164:167], v[60:63]
    ds_read_b64_tr_b16 v[208:209], v10 offset:12288
    v_mfma_f32_16x16x32_bf16 v[64:67], v[144:147], v[164:167], v[64:67]
    ds_read_b64_tr_b16 v[210:211], v10 offset:12800
    v_mfma_f32_16x16x32_bf16 v[68:71], v[148:151], v[164:167], v[68:71]
    ds_read_b128 v[184:187], v5 offset:2048
    v_mfma_f32_16x16x32_bf16 v[72:75], v[152:155], v[164:167], v[72:75]
    ds_read_b128 v[188:191], v5 offset:4096
    v_mfma_f32_16x16x32_bf16 v[92:95], v[152:155], v[168:171], v[92:95]
    ds_read_b64_tr_b16 v[212:213], v13 offset:12288
    v_mfma_f32_16x16x32_bf16 v[88:91], v[148:151], v[168:171], v[88:91]
    ds_read_b64_tr_b16 v[214:215], v13 offset:12800
    v_mfma_f32_16x16x32_bf16 v[84:87], v[144:147], v[168:171], v[84:87]
    ds_read_b128 v[192:195], v5 offset:6144
    v_mfma_f32_16x16x32_bf16 v[80:83], v[140:143], v[168:171], v[80:83]
    ds_read_b128 v[196:199], v5 offset:8192
    v_mfma_f32_16x16x32_bf16 v[76:79], v[136:139], v[168:171], v[76:79]
    ds_read_b64_tr_b16 v[216:217], v10 offset:20480
    v_mfma_f32_16x16x32_bf16 v[96:99], v[136:139], v[172:175], v[96:99]
    ds_read_b64_tr_b16 v[218:219], v10 offset:20992
    v_mfma_f32_16x16x32_bf16 v[100:103], v[140:143], v[172:175], v[100:103]
    ds_read_b64_tr_b16 v[220:221], v13 offset:20480
    v_mfma_f32_16x16x32_bf16 v[104:107], v[144:147], v[172:175], v[104:107]
    ds_read_b64_tr_b16 v[222:223], v13 offset:20992
    v_mfma_f32_16x16x32_bf16 v[108:111], v[148:151], v[172:175], v[108:111]
    v_mfma_f32_16x16x32_bf16 v[112:115], v[152:155], v[172:175], v[112:115]
    v_mfma_f32_16x16x32_bf16 v[132:135], v[152:155], v[176:179], v[132:135]
    v_mfma_f32_16x16x32_bf16 v[128:131], v[148:151], v[176:179], v[128:131]
    v_mfma_f32_16x16x32_bf16 v[124:127], v[144:147], v[176:179], v[124:127]
    v_mfma_f32_16x16x32_bf16 v[120:123], v[140:143], v[176:179], v[120:123]
    v_mfma_f32_16x16x32_bf16 v[116:119], v[136:139], v[176:179], v[116:119]
    s_waitcnt lgkmcnt(0)
    s_barrier
    v_mfma_f32_16x16x32_bf16 v[56:59], v[180:183], v[208:211], v[56:59]
    ds_read_b32 v176, v1 offset:256
    v_mfma_f32_16x16x32_bf16 v[60:63], v[184:187], v[208:211], v[60:63]
    ds_read_b32 v178, v1 offset:320
    v_mfma_f32_16x16x32_bf16 v[64:67], v[188:191], v[208:211], v[64:67]
    ds_read_b32 v12, v1 offset:512
    v_mfma_f32_16x16x32_bf16 v[68:71], v[192:195], v[208:211], v[68:71]
    ds_read_b32 v14, v1 offset:576
    v_mfma_f32_16x16x32_bf16 v[72:75], v[196:199], v[208:211], v[72:75]
    ds_read_b128 v[136:139], v3 offset:0
    v_mfma_f32_16x16x32_bf16 v[92:95], v[196:199], v[212:215], v[92:95]
    ds_read_b128 v[156:159], v3 offset:640
    v_mfma_f32_16x16x32_bf16 v[88:91], v[192:195], v[212:215], v[88:91]
    ds_read_b128 v[140:143], v3 offset:64
    v_mfma_f32_16x16x32_bf16 v[84:87], v[188:191], v[212:215], v[84:87]
    ds_read_b128 v[160:163], v3 offset:704
    v_mfma_f32_16x16x32_bf16 v[80:83], v[184:187], v[212:215], v[80:83]
    ds_read_b128 v[144:147], v3 offset:128
    v_mfma_f32_16x16x32_bf16 v[76:79], v[180:183], v[212:215], v[76:79]
    ds_read_b128 v[164:167], v3 offset:768
    v_mfma_f32_16x16x32_bf16 v[96:99], v[180:183], v[216:219], v[96:99]
    ds_read_b128 v[148:151], v3 offset:192
    v_mfma_f32_16x16x32_bf16 v[100:103], v[184:187], v[216:219], v[100:103]
    ds_read_b128 v[168:171], v3 offset:832
    v_mfma_f32_16x16x32_bf16 v[104:107], v[188:191], v[216:219], v[104:107]
    ds_read_b128 v[152:155], v3 offset:256
    v_mfma_f32_16x16x32_bf16 v[108:111], v[192:195], v[216:219], v[108:111]
    ds_read_b128 v[172:175], v3 offset:896
    v_mfma_f32_16x16x32_bf16 v[112:115], v[196:199], v[216:219], v[112:115]
    v_mfma_f32_16x16x32_bf16 v[132:135], v[196:199], v[220:223], v[132:135]
    v_mfma_f32_16x16x32_bf16 v[128:131], v[192:195], v[220:223], v[128:131]
    v_mfma_f32_16x16x32_bf16 v[124:127], v[188:191], v[220:223], v[124:127]
    v_mfma_f32_16x16x32_bf16 v[120:123], v[184:187], v[220:223], v[120:123]
    v_mfma_f32_16x16x32_bf16 v[116:119], v[180:183], v[220:223], v[116:119]
    s_waitcnt lgkmcnt(0)
L_d0:
    v_pk_mul_f32 v[8:9], v[156:157], v[176:177] op_sel_hi:[1,0]
    v_pk_mul_f32 v[10:11], v[158:159], v[176:177] op_sel_hi:[1,0]
    v_pk_fma_f32 v[56:57], v[56:57], v[136:137], v[8:9]
    v_pk_fma_f32 v[58:59], v[58:59], v[138:139], v[10:11]
    v_exp_f32_e64 v8, v56 clamp
    v_exp_f32_e64 v9, v57 clamp
    v_max_f32 v56, s35, v56
    v_max_f32 v57, s35, v57
    v_fmac_f32 v8, s34, v56
    v_fmac_f32 v9, s34, v57
    v_cvt_pk_bf16_f32 v180, v8, v9
    v_exp_f32_e64 v10, v58 clamp
    v_exp_f32_e64 v11, v59 clamp
    v_max_f32 v58, s35, v58
    v_max_f32 v59, s35, v59
    v_fmac_f32 v10, s34, v58
    v_fmac_f32 v11, s34, v59
    v_cvt_pk_bf16_f32 v181, v10, v11
    v_pk_mul_f32 v[8:9], v[156:157], v[178:179] op_sel_hi:[1,0]
    v_pk_mul_f32 v[10:11], v[158:159], v[178:179] op_sel_hi:[1,0]
    v_pk_fma_f32 v[76:77], v[76:77], v[136:137], v[8:9]
    v_pk_fma_f32 v[78:79], v[78:79], v[138:139], v[10:11]
    v_exp_f32_e64 v8, v76 clamp
    v_exp_f32_e64 v9, v77 clamp
    v_max_f32 v76, s35, v76
    v_max_f32 v77, s35, v77
    v_fmac_f32 v8, s34, v76
    v_fmac_f32 v9, s34, v77
    v_cvt_pk_bf16_f32 v192, v8, v9
    v_exp_f32_e64 v10, v78 clamp
    v_exp_f32_e64 v11, v79 clamp
    v_max_f32 v78, s35, v78
    v_max_f32 v79, s35, v79
    v_fmac_f32 v10, s34, v78
    v_fmac_f32 v11, s34, v79
    v_cvt_pk_bf16_f32 v193, v10, v11
    v_pk_mul_f32 v[8:9], v[156:157], v[12:13] op_sel_hi:[1,0]
    v_pk_mul_f32 v[10:11], v[158:159], v[12:13] op_sel_hi:[1,0]
    v_pk_fma_f32 v[96:97], v[96:97], v[136:137], v[8:9]
    v_pk_fma_f32 v[98:99], v[98:99], v[138:139], v[10:11]
    v_cvt_pk_bf16_f32 v204, v96, v97
    v_cvt_pk_bf16_f32 v205, v98, v99
    v_pk_mul_f32 v[8:9], v[156:157], v[14:15] op_sel_hi:[1,0]
    v_pk_mul_f32 v[10:11], v[158:159], v[14:15] op_sel_hi:[1,0]
    v_pk_fma_f32 v[116:117], v[116:117], v[136:137], v[8:9]
    v_pk_fma_f32 v[118:119], v[118:119], v[138:139], v[10:11]
    v_cvt_pk_bf16_f32 v216, v116, v117
    v_cvt_pk_bf16_f32 v217, v118, v119
    s_cbranch_execz L_dryret
L_d1:
    v_pk_mul_f32 v[8:9], v[160:161], v[176:177] op_sel_hi:[1,0]
    v_pk_mul_f32 v[10:11], v[162:163], v[176:177] op_sel_hi:[1,0]
    v_pk_fma_f32 v[60:61], v[60:61], v[140:141], v[8:9]
    v_pk_fma_f32 v[62:63], v[62:63], v[142:143], v[10:11]
    v_exp_f32_e64 v8, v60 clamp
    v_exp_f32_e64 v9, v61 clamp
    v_max_f32 v60, s35, v60
    v_max_f32 v61, s35, v61
    v_fmac_f32 v8, s34, v60
    v_fmac_f32 v9, s34, v61
    v_cvt_pk_bf16_f32 v182, v8, v9
    v_exp_f32_e64 v10, v62 clamp
    v_exp_f32_e64 v11, v63 clamp
    v_max_f32 v62, s35, v62
    v_max_f32 v63, s35, v63
    v_fmac_f32 v10, s34, v62
    v_fmac_f32 v11, s34, v63
    v_cvt_pk_bf16_f32 v183, v10, v11
    v_pk_mul_f32 v[8:9], v[160:161], v[178:179] op_sel_hi:[1,0]
    v_pk_mul_f32 v[10:11], v[162:163], v[178:179] op_sel_hi:[1,0]
    v_pk_fma_f32 v[80:81], v[80:81], v[140:141], v[8:9]
    v_pk_fma_f32 v[82:83], v[82:83], v[142:143], v[10:11]
    v_exp_f32_e64 v8, v80 clamp
    v_exp_f32_e64 v9, v81 clamp
    v_max_f32 v80, s35, v80
    v_max_f32 v81, s35, v81
    v_fmac_f32 v8, s34, v80
    v_fmac_f32 v9, s34, v81
    v_cvt_pk_bf16_f32 v194, v8, v9
    v_exp_f32_e64 v10, v82 clamp
    v_exp_f32_e64 v11, v83 clamp
    v_max_f32 v82, s35, v82
    v_max_f32 v83, s35, v83
    v_fmac_f32 v10, s34, v82
    v_fmac_f32 v11, s34, v83
    v_cvt_pk_bf16_f32 v195, v10, v11
    v_pk_mul_f32 v[8:9], v[160:161], v[12:13] op_sel_hi:[1,0]
    v_pk_mul_f32 v[10:11], v[162:163], v[12:13] op_sel_hi:[1,0]
    v_pk_fma_f32 v[100:101], v[100:101], v[140:141], v[8:9]
    v_pk_fma_f32 v[102:103], v[102:103], v[142:143], v[10:11]
    v_cvt_pk_bf16_f32 v206, v100, v101
    v_cvt_pk_bf16_f32 v207, v102, v103
    v_pk_mul_f32 v[8:9], v[160:161], v[14:15] op_sel_hi:[1,0]
    v_pk_mul_f32 v[10:11], v[162:163], v[14:15] op_sel_hi:[1,0]
    v_pk_fma_f32 v[120:121], v[120:121], v[140:141], v[8:9]
    v_pk_fma_f32 v[122:123], v[122:123], v[142:143], v[10:11]
    v_cvt_pk_bf16_f32 v218, v120, v121
    v_cvt_pk_bf16_f32 v219, v122, v123
    s_cbranch_execz L_dryret
    s_nop 0
    v_mfma_f32_16x16x32_bf16 v[228:231], v[180:183], v[204:207], 0
    v_mfma_f32_16x16x32_bf16 v[236:239], v[180:183], v[216:219], 0
    v_mfma_f32_16x16x32_bf16 v[244:247], v[180:183], v[252:255], 0
    v_mfma_f32_16x16x32_bf16 v[232:235], v[192:195], v[204:207], 0
    v_mfma_f32_16x16x32_bf16 v[240:243], v[192:195], v[216:219], 0
    v_mfma_f32_16x16x32_bf16 v[248:251], v[192:195], v[252:255], 0
L_d2:
    v_pk_mul_f32 v[8:9], v[164:165], v[176:177] op_sel_hi:[1,0]
    v_pk_mul_f32 v[10:11], v[166:167], v[176:177] op_sel_hi:[1,0]
    v_pk_fma_f32 v[64:65], v[64:65], v[144:145], v[8:9]
    v_pk_fma_f32 v[66:67], v[66:67], v[146:147], v[10:11]
    v_exp_f32_e64 v8, v64 clamp
    v_exp_f32_e64 v9, v65 clamp
    v_max_f32 v64, s35, v64
    v_max_f32 v65, s35, v65
    v_fmac_f32 v8, s34, v64
    v_fmac_f32 v9, s34, v65
    v_cvt_pk_bf16_f32 v184, v8, v9
    v_exp_f32_e64 v10, v66 clamp
    v_exp_f32_e64 v11, v67 clamp
    v_max_f32 v66, s35, v66
    v_max_f32 v67, s35, v67
    v_fmac_f32 v10, s34, v66
    v_fmac_f32 v11, s34, v67
    v_cvt_pk_bf16_f32 v185, v10, v11
    v_pk_mul_f32 v[8:9], v[164:165], v[178:179] op_sel_hi:[1,0]
    v_pk_mul_f32 v[10:11], v[166:167], v[178:179] op_sel_hi:[1,0]
    v_pk_fma_f32 v[84:85], v[84:85], v[144:145], v[8:9]
    v_pk_fma_f32 v[86:87], v[86:87], v[146:147], v[10:11]
    v_exp_f32_e64 v8, v84 clamp
    v_exp_f32_e64 v9, v85 clamp
    v_max_f32 v84, s35, v84
    v_max_f32 v85, s35, v85
    v_fmac_f32 v8, s34, v84
    v_fmac_f32 v9, s34, v85
    v_cvt_pk_bf16_f32 v196, v8, v9
    v_exp_f32_e64 v10, v86 clamp
    v_exp_f32_e64 v11, v87 clamp
    v_max_f32 v86, s35, v86
    v_max_f32 v87, s35, v87
    v_fmac_f32 v10, s34, v86
    v_fmac_f32 v11, s34, v87
    v_cvt_pk_bf16_f32 v197, v10, v11
    v_pk_mul_f32 v[8:9], v[164:165], v[12:13] op_sel_hi:[1,0]
    v_pk_mul_f32 v[10:11], v[166:167], v[12:13] op_sel_hi:[1,0]
    v_pk_fma_f32 v[104:105], v[104:105], v[144:145], v[8:9]
    v_pk_fma_f32 v[106:107], v[106:107], v[146:147], v[10:11]
    v_cvt_pk_bf16_f32 v208, v104, v105
    v_cvt_pk_bf16_f32 v209, v106, v107
    v_pk_mul_f32 v[8:9], v[164:165], v[14:15] op_sel_hi:[1,0]
    v_pk_mul_f32 v[10:11], v[166:167], v[14:15] op_sel_hi:[1,0]
    v_pk_fma_f32 v[124:125], v[124:125], v[144:145], v[8:9]
    v_pk_fma_f32 v[126:127], v[126:127], v[146:147], v[10:11]
    v_cvt_pk_bf16_f32 v220, v124, v125
    v_cvt_pk_bf16_f32 v221, v126, v127
    s_cbranch_execz L_dryret
L_d3:
    v_pk_mul_f32 v[8:9], v[168:169], v[176:177] op_sel_hi:[1,0]
    v_pk_mul_f32 v[10:11], v[170:171], v[176:177] op_sel_hi:[1,0]
    v_pk_fma_f32 v[68:69], v[68:69], v[148:149], v[8:9]
    v_pk_fma_f32 v[70:71], v[70:71], v[150:151], v[10:11]
    v_exp_f32_e64 v8, v68 clamp
    v_exp_f32_e64 v9, v69 clamp
    v_max_f32 v68, s35, v68
    v_max_f32 v69, s35, v69
    v_fmac_f32 v8, s34, v68
    v_fmac_f32 v9, s34, v69
    v_cvt_pk_bf16_f32 v186, v8, v9
    v_exp_f32_e64 v10, v70 clamp
    v_exp_f32_e64 v11, v71 clamp
    v_max_f32 v70, s35, v70
    v_max_f32 v71, s35, v71
    v_fmac_f32 v10, s34, v70
    v_fmac_f32 v11, s34, v71
    v_cvt_pk_bf16_f32 v187, v10, v11
    v_and_b32 v186, s59, v186
    v_and_b32 v187, s59, v187
    v_pk_mul_f32 v[8:9], v[168:169], v[178:179] op_sel_hi:[1,0]
    v_pk_mul_f32 v[10:11], v[170:171], v[178:179] op_sel_hi:[1,0]
    v_pk_fma_f32 v[88:89], v[88:89], v[148:149], v[8:9]
    v_pk_fma_f32 v[90:91], v[90:91], v[150:151], v[10:11]
    v_exp_f32_e64 v8, v88 clamp
    v_exp_f32_e64 v9, v89 clamp
    v_max_f32 v88, s35, v88
    v_max_f32 v89, s35, v89
    v_fmac_f32 v8, s34, v88
    v_fmac_f32 v9, s34, v89
    v_cvt_pk_bf16_f32 v198, v8, v9
    v_exp_f32_e64 v10, v90 clamp
    v_exp_f32_e64 v11, v91 clamp
    v_max_f32 v90, s35, v90
    v_max_f32 v91, s35, v91
    v_fmac_f32 v10, s34, v90
    v_fmac_f32 v11, s34, v91
    v_cvt_pk_bf16_f32 v199, v10, v11
    v_and_b32 v198, s59, v198
    v_and_b32 v199, s59, v199
    v_pk_mul_f32 v[8:9], v[168:169], v[12:13] op_sel_hi:[1,0]
    v_pk_mul_f32 v[10:11], v[170:171], v[12:13] op_sel_hi:[1,0]
    v_pk_fma_f32 v[108:109], v[108:109], v[148:149], v[8:9]
    v_pk_fma_f32 v[110:111], v[110:111], v[150:151], v[10:11]
    v_cvt_pk_bf16_f32 v210, v108, v109
    v_cvt_pk_bf16_f32 v211, v110, v111
    v_and_b32 v210, s59, v210
    v_and_b32 v211, s59, v211
    v_pk_mul_f32 v[8:9], v[168:169], v[14:15] op_sel_hi:[1,0]
    v_pk_mul_f32 v[10:11], v[170:171], v[14:15] op_sel_hi:[1,0]
    v_pk_fma_f32 v[128:129], v[128:129], v[148:149], v[8:9]
    v_pk_fma_f32 v[130:131], v[130:131], v[150:151], v[10:11]
    v_cvt_pk_bf16_f32 v222, v128, v129
    v_cvt_pk_bf16_f32 v223, v130, v131
    v_and_b32 v222, s59, v222
    v_and_b32 v223, s59, v223
    s_cbranch_execz L_dryret
    s_nop 0
    v_mfma_f32_16x16x32_bf16 v[228:231], v[184:187], v[208:211], v[228:231]
    v_mfma_f32_16x16x32_bf16 v[236:239], v[184:187], v[220:223], v[236:239]
    v_mfma_f32_16x16x32_bf16 v[244:247], v[184:187], v[252:255], v[244:247]
    v_mfma_f32_16x16x32_bf16 v[232:235], v[196:199], v[208:211], v[232:235]
    v_mfma_f32_16x16x32_bf16 v[240:243], v[196:199], v[220:223], v[240:243]
    v_mfma_f32_16x16x32_bf16 v[248:251], v[196:199], v[252:255], v[248:251]
L_d4:
    v_mov_b32 v190, 0
    v_mov_b32 v191, 0
    v_mov_b32 v202, 0
    v_mov_b32 v203, 0
    v_mov_b32 v214, 0
    v_mov_b32 v215, 0
    v_mov_b32 v226, 0
    v_mov_b32 v227, 0
    v_pk_mul_f32 v[8:9], v[172:173], v[176:177] op_sel_hi:[1,0]
    v_pk_mul_f32 v[10:11], v[174:175], v[176:177] op_sel_hi:[1,0]
    v_pk_fma_f32 v[72:73], v[72:73], v[152:153], v[8:9]
    v_pk_fma_f32 v[74:75], v[74:75], v[154:155], v[10:11]
    v_exp_f32_e64 v8, v72 clamp
    v_exp_f32_e64 v9, v73 clamp
    v_max_f32 v72, s35, v72
    v_max_f32 v73, s35, v73
    v_fmac_f32 v8, s34, v72
    v_fmac_f32 v9, s34, v73
    v_cvt_pk_bf16_f32 v188, v8, v9
    v_exp_f32_e64 v10, v74 clamp
    v_exp_f32_e64 v11, v75 clamp
    v_max_f32 v74, s35, v74
    v_max_f32 v75, s35, v75
    v_fmac_f32 v10, s34, v74
    v_fmac_f32 v11, s34, v75
    v_cvt_pk_bf16_f32 v189, v10, v11
    v_and_b32 v188, s59, v188
    v_and_b32 v189, s59, v189
    v_pk_mul_f32 v[8:9], v[172:173], v[178:179] op_sel_hi:[1,0]
    v_pk_mul_f32 v[10:11], v[174:175], v[178:179] op_sel_hi:[1,0]
    v_pk_fma_f32 v[92:93], v[92:93], v[152:153], v[8:9]
    v_pk_fma_f32 v[94:95], v[94:95], v[154:155], v[10:11]
    v_exp_f32_e64 v8, v92 clamp
    v_exp_f32_e64 v9, v93 clamp
    v_max_f32 v92, s35, v92
    v_max_f32 v93, s35, v93
    v_fmac_f32 v8, s34, v92
    v_fmac_f32 v9, s34, v93
    v_cvt_pk_bf16_f32 v200, v8, v9
    v_exp_f32_e64 v10, v94 clamp
    v_exp_f32_e64 v11, v95 clamp
    v_max_f32 v94, s35, v94
    v_max_f32 v95, s35, v95
    v_fmac_f32 v10, s34, v94
    v_fmac_f32 v11, s34, v95
    v_cvt_pk_bf16_f32 v201, v10, v11
    v_and_b32 v200, s59, v200
    v_and_b32 v201, s59, v201
    v_pk_mul_f32 v[8:9], v[172:173], v[12:13] op_sel_hi:[1,0]
    v_pk_mul_f32 v[10:11], v[174:175], v[12:13] op_sel_hi:[1,0]
    v_pk_fma_f32 v[112:113], v[112:113], v[152:153], v[8:9]
    v_pk_fma_f32 v[114:115], v[114:115], v[154:155], v[10:11]
    v_cvt_pk_bf16_f32 v212, v112, v113
    v_cvt_pk_bf16_f32 v213, v114, v115
    v_and_b32 v212, s59, v212
    v_and_b32 v213, s59, v213
    v_pk_mul_f32 v[8:9], v[172:173], v[14:15] op_sel_hi:[1,0]
    v_pk_mul_f32 v[10:11], v[174:175], v[14:15] op_sel_hi:[1,0]
    v_pk_fma_f32 v[132:133], v[132:133], v[152:153], v[8:9]
    v_pk_fma_f32 v[134:135], v[134:135], v[154:155], v[10:11]
    v_cvt_pk_bf16_f32 v224, v132, v133
    v_cvt_pk_bf16_f32 v225, v134, v135
    v_and_b32 v224, s59, v224
    v_and_b32 v225, s59, v225
    s_cbranch_execz L_dryret
    s_nop 0
    v_mfma_f32_16x16x32_bf16 v[228:231], v[188:191], v[212:215], v[228:231]
    v_mfma_f32_16x16x32_bf16 v[236:239], v[188:191], v[224:227], v[236:239]
    v_mfma_f32_16x16x32_bf16 v[244:247], v[188:191], v[252:255], v[244:247]
    v_mfma_f32_16x16x32_bf16 v[232:235], v[200:203], v[212:215], v[232:235]
    v_mfma_f32_16x16x32_bf16 v[240:243], v[200:203], v[224:227], v[240:243]
    v_mfma_f32_16x16x32_bf16 v[248:251], v[200:203], v[252:255], v[248:251]
    s_lshl_b32 s38, s23, 1
    s_add_u32 s38, s38, s27
    v_mov_b32 v4, 137280
    v_mov_b32 v10, 1
    s_lshl_b32 s31, s25, 2
    v_add_u32 v9, s31, v4
    v_xor_b32 v8, 8, v9
    s_lshl_b32 s33, s27, 11
    s_add_u32 s33, s33, 131072
    v_add_u32 v1, s33, v2
    s_lshl_b32 s33, s27, 12
    s_add_u32 s33, s33, 139264
    v_add_u32 v3, s33, v2
    s_lshl_b32 s30, s38, 4
    s_add_u32 s30, s30, s22
    s_lshl_b32 s31, s30, 11
    s_lshl_b32 s32, s26, 10
    s_add_u32 s31, s31, s32
    s_add_u32 s31, s31, 0x400000
    s_lshl_b32 s30, s30, 7
    s_add_u32 s30, s30, 0x500000
    s_lshl_b32 s32, s38, 7
    s_add_u32 s32, s32, 0x5b0000
    s_cmp_eq_u32 s26, 0
    s_cbranch_scc1 L_wr0
    ds_write_b128 v3, v[228:231]
    ds_write_b128 v3, v[232:235] offset:1024
    ds_write_b128 v3, v[244:247] offset:2048
    ds_write_b128 v3, v[248:251] offset:3072
    ds_write_b32 v9, v10
    s_mov_b32 s39, 1048576
LW_5:
    ds_read_b32 v5, v8 offset:0
    s_waitcnt lgkmcnt(0)
    v_cmp_eq_u32 vcc, 0, v5
    s_cbranch_vccz LE_6
    s_sub_u32 s39, s39, 1
    s_cbranch_scc0 LW_5
LE_6:
    ds_read_b128 v[136:139], v1
    ds_read_b128 v[140:143], v1 offset:1024
    s_waitcnt lgkmcnt(0)
    v_pk_add_f32 v[236:237], v[236:237], v[136:137]
    v_pk_add_f32 v[238:239], v[238:239], v[138:139]
    v_pk_add_f32 v[240:241], v[240:241], v[140:141]
    v_pk_add_f32 v[242:243], v[242:243], v[142:143]
    v_cvt_pk_bf16_f32 v180, v236, v237
    v_cvt_pk_bf16_f32 v181, v238, v239
    v_cvt_pk_bf16_f32 v182, v240, v241
    v_cvt_pk_bf16_f32 v183, v242, v243
    buffer_store_dwordx4 v[180:183], v2, s[16:19], s31 offen sc1
    s_branch L_kvflag
L_wr0:
    ds_write_b128 v1, v[236:239]
    ds_write_b128 v1, v[240:243] offset:1024
    ds_write_b32 v9, v10
    s_mov_b32 s39, 1048576
LW_7:
    ds_read_b32 v5, v8 offset:0
    s_waitcnt lgkmcnt(0)
    v_cmp_eq_u32 vcc, 0, v5
    s_cbranch_vccz LE_8
    s_sub_u32 s39, s39, 1
    s_cbranch_scc0 LW_7
LE_8:
    ds_read_b128 v[136:139], v3 offset:0
    ds_read_b128 v[140:143], v3 offset:1024
    ds_read_b128 v[144:147], v3 offset:2048
    ds_read_b128 v[148:151], v3 offset:3072
    v_lshlrev_b32 v5, 1, v0
    s_waitcnt lgkmcnt(2)
    v_pk_add_f32 v[228:229], v[228:229], v[136:137]
    v_pk_add_f32 v[230:231], v[230:231], v[138:139]
    v_pk_add_f32 v[232:233], v[232:233], v[140:141]
    v_pk_add_f32 v[234:235], v[234:235], v[142:143]
    v_cvt_pk_bf16_f32 v180, v228, v229
    v_cvt_pk_bf16_f32 v181, v230, v231
    v_cvt_pk_bf16_f32 v182, v232, v233
    v_cvt_pk_bf16_f32 v183, v234, v235
    buffer_store_dwordx4 v[180:183], v2, s[16:19], s31 offen sc1
    s_waitcnt lgkmcnt(0)
    v_pk_add_f32 v[244:245], v[244:245], v[144:145]
    v_pk_add_f32 v[246:247], v[246:247], v[146:147]
    v_pk_add_f32 v[248:249], v[248:249], v[148:149]
    v_pk_add_f32 v[250:251], v[250:251], v[150:151]
    s_mov_b32 exec_lo, 0x00010001
    s_mov_b32 exec_hi, 0x00010001
    buffer_store_dwordx4 v[244:247], v5, s[16:19], s30 offen sc1
    buffer_store_dwordx4 v[248:251], v5, s[16:19], s30 offen offset:16 sc1
    s_mov_b64 exec, -1
L_kvflag:
    ds_read_b32 v156, v6 offset:0
    ds_read_b32 v166, v6 offset:640
    ds_read_b32 v158, v6 offset:64
    ds_read_b32 v168, v6 offset:704
    ds_read_b32 v160, v6 offset:128
    ds_read_b32 v170, v6 offset:768
    ds_read_b32 v162, v6 offset:192
    ds_read_b32 v172, v6 offset:832
    ds_read_b32 v164, v6 offset:256
    ds_read_b32 v174, v6 offset:896
    ds_read_b128 v[148:151], v7 offset:0
    ds_read_b128 v[152:155], v7 offset:64
    s_mul_i32 s30, s26, 10240
    v_and_b32 v66, 15, v0
    v_lshrrev_b32 v57, 4, v0
    v_lshrrev_b32 v67, 1, v66
    v_xor_b32 v67, v67, v57
    v_lshlrev_b32 v67, 4, v67
    v_lshlrev_b32 v66, 7, v66
    v_add_u32 v66, v66, v67
    v_add_u32 v56, s30, v66
    v_xor_b32 v57, 64, v56
    v_add_u32 v58, 90112, v56
    v_add_u32 v59, 90112, v57
    v_lshrrev_b32 v66, 4, v0
    v_lshlrev_b32 v66, 10, v66
    v_bfe_u32 v124, v0, 2, 2
    v_lshlrev_b32 v67, 7, v124
    v_add_u32 v66, v66, v67
    v_lshrrev_b32 v124, 1, v124
    v_xor_b32 v124, s27, v124
    v_lshlrev_b32 v124, 1, v124
    v_bfe_u32 v67, v0, 4, 1
    v_or_b32 v124, v124, v67
    v_lshlrev_b32 v124, 5, v124
    v_add_u32 v66, v66, v124
    v_and_b32 v124, 3, v0
    v_lshlrev_b32 v124, 3, v124
    v_add_u32 v60, v66, v124
    v_add_u32 v62, 110592, v60
    v_add_u32 v61, 65536, v60
    v_add_u32 v60, 20480, v60
    v_xor_b32 v65, 32, v62
    v_xor_b32 v64, 32, v61
    v_xor_b32 v63, 32, v60
    ds_read_b128 v[68:71], v56 offset:45056
    ds_read_b64_tr_b16 v[88:89], v61 offset:0
    ds_read_b64_tr_b16 v[90:91], v61 offset:512
    ds_read_b128 v[72:75], v56 offset:47104
    ds_read_b128 v[76:79], v56 offset:49152
    ds_read_b64_tr_b16 v[92:93], v64 offset:0
    ds_read_b64_tr_b16 v[94:95], v64 offset:512
    ds_read_b128 v[80:83], v56 offset:51200
    ds_read_b128 v[84:87], v56 offset:53248
    s_waitcnt lgkmcnt(0)
    v_mfma_f32_16x16x32_bf16 v[16:19], v[88:91], v[68:71], v[16:19]
    ds_read_b128 v[96:99], v57 offset:45056
    v_mfma_f32_16x16x32_bf16 v[20:23], v[88:91], v[72:75], v[20:23]
    ds_read_b64_tr_b16 v[116:117], v61 offset:4096
    v_mfma_f32_16x16x32_bf16 v[24:27], v[88:91], v[76:79], v[24:27]
    ds_read_b64_tr_b16 v[118:119], v61 offset:4608
    v_mfma_f32_16x16x32_bf16 v[28:31], v[88:91], v[80:83], v[28:31]
    ds_read_b128 v[100:103], v57 offset:47104
    v_mfma_f32_16x16x32_bf16 v[32:35], v[88:91], v[84:87], v[32:35]
    ds_read_b128 v[104:107], v57 offset:49152
    v_mfma_f32_16x16x32_bf16 v[52:55], v[92:95], v[84:87], v[52:55]
    ds_read_b64_tr_b16 v[120:121], v64 offset:4096
    v_mfma_f32_16x16x32_bf16 v[48:51], v[92:95], v[80:83], v[48:51]
    ds_read_b64_tr_b16 v[122:123], v64 offset:4608
    v_mfma_f32_16x16x32_bf16 v[44:47], v[92:95], v[76:79], v[44:47]
    ds_read_b128 v[108:111], v57 offset:51200
    v_mfma_f32_16x16x32_bf16 v[40:43], v[92:95], v[72:75], v[40:43]
    ds_read_b128 v[112:115], v57 offset:53248
    v_mfma_f32_16x16x32_bf16 v[36:39], v[92:95], v[68:71], v[36:39]
    s_waitcnt lgkmcnt(0)
    v_mfma_f32_16x16x32_bf16 v[16:19], v[116:119], v[96:99], v[16:19]
    ds_read_b128 v[68:71], v58 offset:0
    v_mfma_f32_16x16x32_bf16 v[20:23], v[116:119], v[100:103], v[20:23]
    ds_read_b64_tr_b16 v[88:89], v62 offset:0
    v_mfma_f32_16x16x32_bf16 v[24:27], v[116:119], v[104:107], v[24:27]
    ds_read_b64_tr_b16 v[90:91], v62 offset:512
    v_mfma_f32_16x16x32_bf16 v[28:31], v[116:119], v[108:111], v[28:31]
    ds_read_b128 v[72:75], v58 offset:2048
    v_mfma_f32_16x16x32_bf16 v[32:35], v[116:119], v[112:115], v[32:35]
    ds_read_b128 v[76:79], v58 offset:4096
    v_mfma_f32_16x16x32_bf16 v[52:55], v[120:123], v[112:115], v[52:55]
    ds_read_b64_tr_b16 v[92:93], v65 offset:0
    v_mfma_f32_16x16x32_bf16 v[48:51], v[120:123], v[108:111], v[48:51]
    ds_read_b64_tr_b16 v[94:95], v65 offset:512
    v_mfma_f32_16x16x32_bf16 v[44:47], v[120:123], v[104:107], v[44:47]
    ds_read_b128 v[80:83], v58 offset:6144
    v_mfma_f32_16x16x32_bf16 v[40:43], v[120:123], v[100:103], v[40:43]
    ds_read_b128 v[84:87], v58 offset:8192
    v_mfma_f32_16x16x32_bf16 v[36:39], v[120:123], v[96:99], v[36:39]
    s_waitcnt lgkmcnt(0)
    v_mfma_f32_16x16x32_bf16 v[16:19], v[88:91], v[68:71], v[16:19]
    ds_read_b128 v[96:99], v59 offset:0
    v_mfma_f32_16x16x32_bf16 v[20:23], v[88:91], v[72:75], v[20:23]
    ds_read_b64_tr_b16 v[116:117], v62 offset:4096
    v_mfma_f32_16x16x32_bf16 v[24:27], v[88:91], v[76:79], v[24:27]
    ds_read_b64_tr_b16 v[118:119], v62 offset:4608
    v_mfma_f32_16x16x32_bf16 v[28:31], v[88:91], v[80:83], v[28:31]
    ds_read_b128 v[100:103], v59 offset:2048
    v_mfma_f32_16x16x32_bf16 v[32:35], v[88:91], v[84:87], v[32:35]
    ds_read_b128 v[104:107], v59 offset:4096
    v_mfma_f32_16x16x32_bf16 v[52:55], v[92:95], v[84:87], v[52:55]
    ds_read_b64_tr_b16 v[120:121], v65 offset:4096
    v_mfma_f32_16x16x32_bf16 v[48:51], v[92:95], v[80:83], v[48:51]
    ds_read_b64_tr_b16 v[122:123], v65 offset:4608
    v_mfma_f32_16x16x32_bf16 v[44:47], v[92:95], v[76:79], v[44:47]
    ds_read_b128 v[108:111], v59 offset:6144
    v_mfma_f32_16x16x32_bf16 v[40:43], v[92:95], v[72:75], v[40:43]
    ds_read_b128 v[112:115], v59 offset:8192
    v_mfma_f32_16x16x32_bf16 v[36:39], v[92:95], v[68:71], v[36:39]
    s_waitcnt lgkmcnt(0)
    v_mfma_f32_16x16x32_bf16 v[16:19], v[116:119], v[96:99], v[16:19]
    ds_read_b128 v[68:71], v56 offset:0
    v_mfma_f32_16x16x32_bf16 v[20:23], v[116:119], v[100:103], v[20:23]
    ds_read_b64_tr_b16 v[88:89], v60 offset:0
    v_mfma_f32_16x16x32_bf16 v[24:27], v[116:119], v[104:107], v[24:27]
    ds_read_b64_tr_b16 v[90:91], v60 offset:512
    v_mfma_f32_16x16x32_bf16 v[28:31], v[116:119], v[108:111], v[28:31]
    ds_read_b128 v[72:75], v56 offset:2048
    v_mfma_f32_16x16x32_bf16 v[32:35], v[116:119], v[112:115], v[32:35]
    ds_read_b128 v[76:79], v56 offset:4096
    v_mfma_f32_16x16x32_bf16 v[52:55], v[120:123], v[112:115], v[52:55]
    ds_read_b64_tr_b16 v[92:93], v63 offset:0
    v_mfma_f32_16x16x32_bf16 v[48:51], v[120:123], v[108:111], v[48:51]
    ds_read_b64_tr_b16 v[94:95], v63 offset:512
    v_mfma_f32_16x16x32_bf16 v[44:47], v[120:123], v[104:107], v[44:47]
    ds_read_b128 v[80:83], v56 offset:6144
    v_mfma_f32_16x16x32_bf16 v[40:43], v[120:123], v[100:103], v[40:43]
    ds_read_b128 v[84:87], v56 offset:8192
    v_mfma_f32_16x16x32_bf16 v[36:39], v[120:123], v[96:99], v[36:39]
    v_mov_b32 v5, 1
    s_mov_b64 exec, 1
    s_waitcnt vmcnt(0)
    buffer_atomic_add v5, v2, s[16:19], s32 offen sc1
    s_mov_b64 exec, -1
    ds_write_b32 v4, v10 offset:36
    s_waitcnt lgkmcnt(0)
    v_mfma_f32_16x16x32_bf16 v[16:19], v[88:91], v[68:71], v[16:19]
    ds_read_b128 v[96:99], v57 offset:0
    v_mfma_f32_16x16x32_bf16 v[20:23], v[88:91], v[72:75], v[20:23]
    ds_read_b64_tr_b16 v[116:117], v60 offset:4096
    v_mfma_f32_16x16x32_bf16 v[24:27], v[88:91], v[76:79], v[24:27]
    ds_read_b64_tr_b16 v[118:119], v60 offset:4608
    v_mfma_f32_16x16x32_bf16 v[28:31], v[88:91], v[80:83], v[28:31]
    ds_read_b128 v[100:103], v57 offset:2048
    v_mfma_f32_16x16x32_bf16 v[32:35], v[88:91], v[84:87], v[32:35]
    ds_read_b128 v[104:107], v57 offset:4096
    v_mfma_f32_16x16x32_bf16 v[52:55], v[92:95], v[84:87], v[52:55]
    ds_read_b64_tr_b16 v[120:121], v63 offset:4096
    v_mfma_f32_16x16x32_bf16 v[48:51], v[92:95], v[80:83], v[48:51]
    ds_read_b64_tr_b16 v[122:123], v63 offset:4608
    v_mfma_f32_16x16x32_bf16 v[44:47], v[92:95], v[76:79], v[44:47]
    ds_read_b128 v[108:111], v57 offset:6144
    v_mfma_f32_16x16x32_bf16 v[40:43], v[92:95], v[72:75], v[40:43]
    ds_read_b128 v[112:115], v57 offset:8192
    v_mfma_f32_16x16x32_bf16 v[36:39], v[92:95], v[68:71], v[36:39]
    s_waitcnt lgkmcnt(0)
    v_mfma_f32_16x16x32_bf16 v[16:19], v[116:119], v[96:99], v[16:19]
    v_mfma_f32_16x16x32_bf16 v[20:23], v[116:119], v[100:103], v[20:23]
    v_mfma_f32_16x16x32_bf16 v[24:27], v[116:119], v[104:107], v[24:27]
    v_mfma_f32_16x16x32_bf16 v[28:31], v[116:119], v[108:111], v[28:31]
    v_mfma_f32_16x16x32_bf16 v[32:35], v[116:119], v[112:115], v[32:35]
    v_mfma_f32_16x16x32_bf16 v[52:55], v[120:123], v[112:115], v[52:55]
    v_mfma_f32_16x16x32_bf16 v[48:51], v[120:123], v[108:111], v[48:51]
    v_mfma_f32_16x16x32_bf16 v[44:47], v[120:123], v[104:107], v[44:47]
    v_mfma_f32_16x16x32_bf16 v[40:43], v[120:123], v[100:103], v[40:43]
    v_mfma_f32_16x16x32_bf16 v[36:39], v[120:123], v[96:99], v[36:39]
    s_mov_b64 exec, 1
    ds_add_u32 v4, v10 offset:48
    s_mov_b64 exec, -1
    s_nop 4
    ds_write_b32 v4, v10 offset:36
    s_mov_b32 s40, s80
    s_and_b32 s41, s81, 0xffff
    s_mov_b32 s42, 0x400000
    s_mov_b32 s43, 0x20000
    s_lshl_b32 s71, s28, 3
    s_add_u32 s71, s71, s25
    s_lshl_b32 s56, s28, 18
    s_lshl_b32 s69, s25, 10
    s_add_u32 s56, s56, s69
    s_lshl_b32 s71, s71, 4
    v_and_b32 v247, 15, v0
    v_add_u32 v246, s71, v247
    v_lshlrev_b32 v246, 11, v246
    v_bfe_u32 v224, v0, 4, 1
    v_lshlrev_b32 v224, 5, v224
    v_lshrrev_b32 v225, 5, v0
    v_lshlrev_b32 v225, 4, v225
    v_add_u32 v224, v224, v225
    s_lshl_b32 s69, s29, 7
    v_add3_u32 v246, v246, v224, s69
    buffer_load_dwordx4 v[248:251], v246, s[8:11], 0 offen
    buffer_load_dwordx4 v[252:255], v246, s[8:11], 0 offen offset:64
    s_and_b32 s71, s71, 127
    v_add_u32 v247, s71, v247
    v_lshlrev_b32 v224, 3, v247
    v_add_u32 v224, 137344, v224
    v_mov_b32 v225, 137248
    ds_read_b64 v[240:241], v224
    ds_read_b64 v[242:243], v225
    v_lshrrev_b32 v245, 4, v0
    v_lshlrev_b32 v245, 4, v245
    s_xor_b32 s38, s38, 2
    s_xor_b32 s23, s23, 1
    v_pk_mul_f32 v[12:13], v[148:149], v[166:167] op_sel_hi:[1,0]
    v_pk_mul_f32 v[14:15], v[150:151], v[166:167] op_sel_hi:[1,0]
    v_pk_fma_f32 v[16:17], v[16:17], v[156:157], v[12:13] op_sel_hi:[1,0,1]
    v_pk_fma_f32 v[18:19], v[18:19], v[156:157], v[14:15] op_sel_hi:[1,0,1]
    v_exp_f32_e64 v12, v16 clamp
    v_exp_f32_e64 v13, v17 clamp
    v_max_f32 v16, s35, v16
    v_max_f32 v17, s35, v17
    v_fmac_f32 v12, s34, v16
    v_fmac_f32 v13, s34, v17
    v_cvt_pk_bf16_f32 v204, v12, v13
    v_exp_f32_e64 v14, v18 clamp
    v_exp_f32_e64 v15, v19 clamp
    v_max_f32 v18, s35, v18
    v_max_f32 v19, s35, v19
    v_fmac_f32 v14, s34, v18
    v_fmac_f32 v15, s34, v19
    v_cvt_pk_bf16_f32 v205, v14, v15
    v_pk_mul_f32 v[12:13], v[152:153], v[166:167] op_sel_hi:[1,0]
    v_pk_mul_f32 v[14:15], v[154:155], v[166:167] op_sel_hi:[1,0]
    v_pk_fma_f32 v[36:37], v[36:37], v[156:157], v[12:13] op_sel_hi:[1,0,1]
    v_pk_fma_f32 v[38:39], v[38:39], v[156:157], v[14:15] op_sel_hi:[1,0,1]
    v_exp_f32_e64 v12, v36 clamp
    v_exp_f32_e64 v13, v37 clamp
    v_max_f32 v36, s35, v36
    v_max_f32 v37, s35, v37
    v_fmac_f32 v12, s34, v36
    v_fmac_f32 v13, s34, v37
    v_cvt_pk_bf16_f32 v206, v12, v13
    v_exp_f32_e64 v14, v38 clamp
    v_exp_f32_e64 v15, v39 clamp
    v_max_f32 v38, s35, v38
    v_max_f32 v39, s35, v39
    v_fmac_f32 v14, s34, v38
    v_fmac_f32 v15, s34, v39
    v_cvt_pk_bf16_f32 v207, v14, v15
    v_pk_mul_f32 v[12:13], v[148:149], v[168:169] op_sel_hi:[1,0]
    v_pk_mul_f32 v[14:15], v[150:151], v[168:169] op_sel_hi:[1,0]
    v_pk_fma_f32 v[20:21], v[20:21], v[158:159], v[12:13] op_sel_hi:[1,0,1]
    v_pk_fma_f32 v[22:23], v[22:23], v[158:159], v[14:15] op_sel_hi:[1,0,1]
    v_exp_f32_e64 v12, v20 clamp
    v_exp_f32_e64 v13, v21 clamp
    v_max_f32 v20, s35, v20
    v_max_f32 v21, s35, v21
    v_fmac_f32 v12, s34, v20
    v_fmac_f32 v13, s34, v21
    v_cvt_pk_bf16_f32 v208, v12, v13
    v_exp_f32_e64 v14, v22 clamp
    v_exp_f32_e64 v15, v23 clamp
    v_max_f32 v22, s35, v22
    v_max_f32 v23, s35, v23
    v_fmac_f32 v14, s34, v22
    v_fmac_f32 v15, s34, v23
    v_cvt_pk_bf16_f32 v209, v14, v15
    v_pk_mul_f32 v[12:13], v[152:153], v[168:169] op_sel_hi:[1,0]
    v_pk_mul_f32 v[14:15], v[154:155], v[168:169] op_sel_hi:[1,0]
    v_pk_fma_f32 v[40:41], v[40:41], v[158:159], v[12:13] op_sel_hi:[1,0,1]
    v_pk_fma_f32 v[42:43], v[42:43], v[158:159], v[14:15] op_sel_hi:[1,0,1]
    v_exp_f32_e64 v12, v40 clamp
    v_exp_f32_e64 v13, v41 clamp
    v_max_f32 v40, s35, v40
    v_max_f32 v41, s35, v41
    v_fmac_f32 v12, s34, v40
    v_fmac_f32 v13, s34, v41
    v_cvt_pk_bf16_f32 v210, v12, v13
    v_exp_f32_e64 v14, v42 clamp
    v_exp_f32_e64 v15, v43 clamp
    v_max_f32 v42, s35, v42
    v_max_f32 v43, s35, v43
    v_fmac_f32 v14, s34, v42
    v_fmac_f32 v15, s34, v43
    v_cvt_pk_bf16_f32 v211, v14, v15
    v_pk_mul_f32 v[12:13], v[148:149], v[170:171] op_sel_hi:[1,0]
    v_pk_mul_f32 v[14:15], v[150:151], v[170:171] op_sel_hi:[1,0]
    v_pk_fma_f32 v[24:25], v[24:25], v[160:161], v[12:13] op_sel_hi:[1,0,1]
    v_pk_fma_f32 v[26:27], v[26:27], v[160:161], v[14:15] op_sel_hi:[1,0,1]
    v_exp_f32_e64 v12, v24 clamp
    v_exp_f32_e64 v13, v25 clamp
    v_max_f32 v24, s35, v24
    v_max_f32 v25, s35, v25
    v_fmac_f32 v12, s34, v24
    v_fmac_f32 v13, s34, v25
    v_cvt_pk_bf16_f32 v212, v12, v13
    v_exp_f32_e64 v14, v26 clamp
    v_exp_f32_e64 v15, v27 clamp
    v_max_f32 v26, s35, v26
    v_max_f32 v27, s35, v27
    v_fmac_f32 v14, s34, v26
    v_fmac_f32 v15, s34, v27
    v_cvt_pk_bf16_f32 v213, v14, v15
    v_pk_mul_f32 v[12:13], v[152:153], v[170:171] op_sel_hi:[1,0]
    v_pk_mul_f32 v[14:15], v[154:155], v[170:171] op_sel_hi:[1,0]
    v_pk_fma_f32 v[44:45], v[44:45], v[160:161], v[12:13] op_sel_hi:[1,0,1]
    v_pk_fma_f32 v[46:47], v[46:47], v[160:161], v[14:15] op_sel_hi:[1,0,1]
    v_exp_f32_e64 v12, v44 clamp
    v_exp_f32_e64 v13, v45 clamp
    v_max_f32 v44, s35, v44
    v_max_f32 v45, s35, v45
    v_fmac_f32 v12, s34, v44
    v_fmac_f32 v13, s34, v45
    v_cvt_pk_bf16_f32 v214, v12, v13
    v_exp_f32_e64 v14, v46 clamp
    v_exp_f32_e64 v15, v47 clamp
    v_max_f32 v46, s35, v46
    v_max_f32 v47, s35, v47
    v_fmac_f32 v14, s34, v46
    v_fmac_f32 v15, s34, v47
    v_cvt_pk_bf16_f32 v215, v14, v15
    v_pk_mul_f32 v[12:13], v[148:149], v[172:173] op_sel_hi:[1,0]
    v_pk_mul_f32 v[14:15], v[150:151], v[172:173] op_sel_hi:[1,0]
    v_pk_fma_f32 v[28:29], v[28:29], v[162:163], v[12:13] op_sel_hi:[1,0,1]
    v_pk_fma_f32 v[30:31], v[30:31], v[162:163], v[14:15] op_sel_hi:[1,0,1]
    v_exp_f32_e64 v12, v28 clamp
    v_exp_f32_e64 v13, v29 clamp
    v_max_f32 v28, s35, v28
    v_max_f32 v29, s35, v29
    v_fmac_f32 v12, s34, v28
    v_fmac_f32 v13, s34, v29
    v_cvt_pk_bf16_f32 v216, v12, v13
    v_exp_f32_e64 v14, v30 clamp
    v_exp_f32_e64 v15, v31 clamp
    v_max_f32 v30, s35, v30
    v_max_f32 v31, s35, v31
    v_fmac_f32 v14, s34, v30
    v_fmac_f32 v15, s34, v31
    v_cvt_pk_bf16_f32 v217, v14, v15
    v_pk_mul_f32 v[12:13], v[152:153], v[172:173] op_sel_hi:[1,0]
    v_pk_mul_f32 v[14:15], v[154:155], v[172:173] op_sel_hi:[1,0]
    v_pk_fma_f32 v[48:49], v[48:49], v[162:163], v[12:13] op_sel_hi:[1,0,1]
    v_pk_fma_f32 v[50:51], v[50:51], v[162:163], v[14:15] op_sel_hi:[1,0,1]
    v_exp_f32_e64 v12, v48 clamp
    v_exp_f32_e64 v13, v49 clamp
    v_max_f32 v48, s35, v48
    v_max_f32 v49, s35, v49
    v_fmac_f32 v12, s34, v48
    v_fmac_f32 v13, s34, v49
    v_cvt_pk_bf16_f32 v218, v12, v13
    v_exp_f32_e64 v14, v50 clamp
    v_exp_f32_e64 v15, v51 clamp
    v_max_f32 v50, s35, v50
    v_max_f32 v51, s35, v51
    v_fmac_f32 v14, s34, v50
    v_fmac_f32 v15, s34, v51
    v_cvt_pk_bf16_f32 v219, v14, v15
    v_pk_mul_f32 v[12:13], v[148:149], v[174:175] op_sel_hi:[1,0]
    v_pk_mul_f32 v[14:15], v[150:151], v[174:175] op_sel_hi:[1,0]
    v_pk_fma_f32 v[32:33], v[32:33], v[164:165], v[12:13] op_sel_hi:[1,0,1]
    v_pk_fma_f32 v[34:35], v[34:35], v[164:165], v[14:15] op_sel_hi:[1,0,1]
    v_exp_f32_e64 v12, v32 clamp
    v_exp_f32_e64 v13, v33 clamp
    v_max_f32 v32, s35, v32
    v_max_f32 v33, s35, v33
    v_fmac_f32 v12, s34, v32
    v_fmac_f32 v13, s34, v33
    v_cvt_pk_bf16_f32 v220, v12, v13
    v_exp_f32_e64 v14, v34 clamp
    v_exp_f32_e64 v15, v35 clamp
    v_max_f32 v34, s35, v34
    v_max_f32 v35, s35, v35
    v_fmac_f32 v14, s34, v34
    v_fmac_f32 v15, s34, v35
    v_cvt_pk_bf16_f32 v221, v14, v15
    v_pk_mul_f32 v[12:13], v[152:153], v[174:175] op_sel_hi:[1,0]
    v_pk_mul_f32 v[14:15], v[154:155], v[174:175] op_sel_hi:[1,0]
    v_pk_fma_f32 v[52:53], v[52:53], v[164:165], v[12:13] op_sel_hi:[1,0,1]
    v_pk_fma_f32 v[54:55], v[54:55], v[164:165], v[14:15] op_sel_hi:[1,0,1]
    v_exp_f32_e64 v12, v52 clamp
    v_exp_f32_e64 v13, v53 clamp
    v_max_f32 v52, s35, v52
    v_max_f32 v53, s35, v53
    v_fmac_f32 v12, s34, v52
    v_fmac_f32 v13, s34, v53
    v_cvt_pk_bf16_f32 v222, v12, v13
    v_exp_f32_e64 v14, v54 clamp
    v_exp_f32_e64 v15, v55 clamp
    v_max_f32 v54, s35, v54
    v_max_f32 v55, s35, v55
    v_fmac_f32 v14, s34, v54
    v_fmac_f32 v15, s34, v55
    v_cvt_pk_bf16_f32 v223, v14, v15
    v_lshlrev_b32 v11, 5, v0
    v_cmp_gt_u32 vcc, 52, v0
    v_mov_b32 v7, 0x7ff00000
    s_lshl_b32 s60, s38, 15
    s_mul_i32 s31, s26, 14336
    v_cndmask_b32 v11, v7, v11, vcc
    s_add_u32 s60, s60, s31
    s_add_u32 s60, s60, 0x400000
    s_add_u32 s61, s60, 4096
    s_add_u32 s62, s60, 8192
    s_add_u32 s63, s60, 12288
    s_cmp_eq_u32 s26, 1
    s_cselect_b32 s63, 0x7ff00000, s63
    s_lshl_b32 s33, s38, 11
    s_add_u32 s33, s33, 0x500000
    s_waitcnt vmcnt(0) lgkmcnt(0)
    v_readfirstlane_b32 s55, v243
    v_mov_b32 v244, v241
    v_permlane16_swap_b32 v248, v250
    v_permlane16_swap_b32 v249, v251
    v_permlane16_swap_b32 v252, v254
    v_permlane16_swap_b32 v253, v255
    v_lshlrev_b32 v224, 16, v248
    v_and_b32 v225, 0xffff0000, v248
    v_add_f32 v248, v224, v240
    v_add_f32 v243, v225, v240
    v_cvt_pk_bf16_f32 v248, v248, v243
    v_and_b32 v243, 0xffff0000, v248
    v_lshlrev_b32 v248, 16, v248
    v_mul_f32 v248, v248, v244
    v_mul_f32 v243, v243, v244
    v_cvt_pk_bf16_f32 v248, v248, v243
    v_and_b32 v243, 0xffff0000, v248
    v_lshlrev_b32 v248, 16, v248
    v_add_f32 v224, v224, v248
    v_add_f32 v225, v225, v243
    v_lshlrev_b32 v226, 16, v249
    v_and_b32 v227, 0xffff0000, v249
    v_add_f32 v249, v226, v240
    v_add_f32 v243, v227, v240
    v_cvt_pk_bf16_f32 v249, v249, v243
    v_and_b32 v243, 0xffff0000, v249
    v_lshlrev_b32 v249, 16, v249
    v_mul_f32 v249, v249, v244
    v_mul_f32 v243, v243, v244
    v_cvt_pk_bf16_f32 v249, v249, v243
    v_and_b32 v243, 0xffff0000, v249
    v_lshlrev_b32 v249, 16, v249
    v_add_f32 v226, v226, v249
    v_add_f32 v227, v227, v243
    v_lshlrev_b32 v228, 16, v250
    v_and_b32 v229, 0xffff0000, v250
    v_add_f32 v250, v228, v240
    v_add_f32 v243, v229, v240
    v_cvt_pk_bf16_f32 v250, v250, v243
    v_and_b32 v243, 0xffff0000, v250
    v_lshlrev_b32 v250, 16, v250
    v_mul_f32 v250, v250, v244
    v_mul_f32 v243, v243, v244
    v_cvt_pk_bf16_f32 v250, v250, v243
    v_and_b32 v243, 0xffff0000, v250
    v_lshlrev_b32 v250, 16, v250
    v_add_f32 v228, v228, v250
    v_add_f32 v229, v229, v243
    v_lshlrev_b32 v230, 16, v251
    v_and_b32 v231, 0xffff0000, v251
    v_add_f32 v251, v230, v240
    v_add_f32 v243, v231, v240
    v_cvt_pk_bf16_f32 v251, v251, v243
    v_and_b32 v243, 0xffff0000, v251
    v_lshlrev_b32 v251, 16, v251
    v_mul_f32 v251, v251, v244
    v_mul_f32 v243, v243, v244
    v_cvt_pk_bf16_f32 v251, v251, v243
    v_and_b32 v243, 0xffff0000, v251
    v_lshlrev_b32 v251, 16, v251
    v_add_f32 v230, v230, v251
    v_add_f32 v231, v231, v243
    v_lshlrev_b32 v232, 16, v252
    v_and_b32 v233, 0xffff0000, v252
    v_add_f32 v252, v232, v240
    v_add_f32 v243, v233, v240
    v_cvt_pk_bf16_f32 v252, v252, v243
    v_and_b32 v243, 0xffff0000, v252
    v_lshlrev_b32 v252, 16, v252
    v_mul_f32 v252, v252, v244
    v_mul_f32 v243, v243, v244
    v_cvt_pk_bf16_f32 v252, v252, v243
    v_and_b32 v243, 0xffff0000, v252
    v_lshlrev_b32 v252, 16, v252
    v_add_f32 v232, v232, v252
    v_add_f32 v233, v233, v243
    v_lshlrev_b32 v234, 16, v253
    v_and_b32 v235, 0xffff0000, v253
    v_add_f32 v253, v234, v240
    v_add_f32 v243, v235, v240
    v_cvt_pk_bf16_f32 v253, v253, v243
    v_and_b32 v243, 0xffff0000, v253
    v_lshlrev_b32 v253, 16, v253
    v_mul_f32 v253, v253, v244
    v_mul_f32 v243, v243, v244
    v_cvt_pk_bf16_f32 v253, v253, v243
    v_and_b32 v243, 0xffff0000, v253
    v_lshlrev_b32 v253, 16, v253
    v_add_f32 v234, v234, v253
    v_add_f32 v235, v235, v243
    v_lshlrev_b32 v236, 16, v254
    v_and_b32 v237, 0xffff0000, v254
    v_add_f32 v254, v236, v240
    v_add_f32 v243, v237, v240
    v_cvt_pk_bf16_f32 v254, v254, v243
    v_and_b32 v243, 0xffff0000, v254
    v_lshlrev_b32 v254, 16, v254
    v_mul_f32 v254, v254, v244
    v_mul_f32 v243, v243, v244
    v_cvt_pk_bf16_f32 v254, v254, v243
    v_and_b32 v243, 0xffff0000, v254
    v_lshlrev_b32 v254, 16, v254
    v_add_f32 v236, v236, v254
    v_add_f32 v237, v237, v243
    v_lshlrev_b32 v238, 16, v255
    v_and_b32 v239, 0xffff0000, v255
    v_add_f32 v255, v238, v240
    v_add_f32 v243, v239, v240
    v_cvt_pk_bf16_f32 v255, v255, v243
    v_and_b32 v243, 0xffff0000, v255
    v_lshlrev_b32 v255, 16, v255
    v_mul_f32 v255, v255, v244
    v_mul_f32 v243, v243, v244
    v_cvt_pk_bf16_f32 v255, v255, v243
    v_and_b32 v243, 0xffff0000, v255
    v_lshlrev_b32 v255, 16, v255
    v_add_f32 v238, v238, v255
    v_add_f32 v239, v239, v243
    v_and_b32 v248, 60, v0
    v_lshlrev_b32 v248, 5, v248
    v_bfe_u32 v249, v0, 3, 2
    v_lshlrev_b32 v249, 5, v249
    v_add_u32 v248, v248, v249
    v_and_b32 v249, 3, v0
    v_lshlrev_b32 v249, 3, v249
    v_add_u32 v248, v248, v249
    v_xor_b32 v249, 32, v248
    v_xor_b32 v250, 64, v248
    v_xor_b32 v251, 96, v248
    v_add_u32 v252, 0x10000, v248
    v_add_u32 v253, 0x10000, v249
    v_add_u32 v254, 0x10000, v250
    v_add_u32 v255, 0x10000, v251
    s_mov_b32 s39, 1048576
LW_9:
    ds_read_b32 v5, v4 offset:32
    s_waitcnt lgkmcnt(0)
    v_cmp_eq_u32 vcc, 0, v5
    s_cbranch_vccz LE_10
    s_sub_u32 s39, s39, 1
    s_cbranch_scc0 LW_9
LE_10:
    buffer_load_dwordx4 v[16:19], v11, s[16:19], s33 offen sc1
    buffer_load_dwordx4 v[20:23], v11, s[16:19], s33 offen offset:16 sc1
    buffer_load_dwordx4 v[72:75], v2, s[16:19], s60 offen offset:0 sc1
    buffer_load_dwordx4 v[76:79], v2, s[16:19], s60 offen offset:1024 sc1
    buffer_load_dwordx4 v[80:83], v2, s[16:19], s60 offen offset:2048 sc1
    buffer_load_dwordx4 v[84:87], v2, s[16:19], s60 offen offset:3072 sc1
    buffer_load_dwordx4 v[88:91], v2, s[16:19], s61 offen offset:0 sc1
    buffer_load_dwordx4 v[92:95], v2, s[16:19], s61 offen offset:1024 sc1
    buffer_load_dwordx4 v[96:99], v2, s[16:19], s61 offen offset:2048 sc1
    buffer_load_dwordx4 v[100:103], v2, s[16:19], s61 offen offset:3072 sc1
    buffer_load_dwordx4 v[104:107], v2, s[16:19], s62 offen offset:0 sc1
    buffer_load_dwordx4 v[108:111], v2, s[16:19], s62 offen offset:1024 sc1
    buffer_load_dwordx4 v[112:115], v2, s[16:19], s62 offen offset:2048 sc1
    buffer_load_dwordx4 v[116:119], v2, s[16:19], s62 offen offset:3072 sc1
    buffer_load_dwordx4 v[120:123], v2, s[16:19], s63 offen offset:0 sc1
    buffer_load_dwordx4 v[124:127], v2, s[16:19], s63 offen offset:1024 sc1
    v_mov_b32 v60, 0
    v_mov_b32 v61, 0
    v_mov_b32 v64, 0
    v_mov_b32 v65, 0
    v_mov_b32 v57, 0x3f80
    v_and_b32 v56, 1, v0
    v_lshlrev_b32 v56, 4, v56
    v_lshlrev_b32 v56, v56, v57
    v_bfe_u32 v57, v0, 2, 2
    v_lshrrev_b32 v6, 4, v0
    v_cmp_eq_u32 vcc, v57, v6
    v_bfe_u32 v57, v0, 1, 1
    v_lshlrev_b32 v6, 2, v6
    v_cndmask_b32 v56, 0, v56, vcc
    v_cmp_eq_u32 vcc, 0, v57
    s_nop 1
    v_cndmask_b32 v62, 0, v56, vcc
    v_cndmask_b32 v63, v56, 0, vcc
    s_lshl_b32 s30, s25, 12
    s_add_u32 s30, s30, 147456
    v_add_u32 v3, s30, v2
    v_xor_b32 v7, 8192, v3
    s_mul_i32 s30, s37, 5
    s_mov_b32 s48, s30
    s_lshl_b32 s30, s30, 5
    s_add_u32 s30, s30, s38
    s_lshl_b32 s30, s30, 10
    s_lshl_b32 s49, s38, 13
    s_mov_b32 s44, s16
    s_mov_b32 s45, s17
    s_mov_b32 s46, 0x400000
    s_mov_b32 s47, 0x20000
    s_nop 0
    s_waitcnt vmcnt(14)
    v_add_f32_dpp v16, v16, v16 row_ror:4 row_mask:0xf bank_mask:0xf
    v_add_f32_dpp v17, v17, v17 row_ror:4 row_mask:0xf bank_mask:0xf
    v_add_f32_dpp v18, v18, v18 row_ror:4 row_mask:0xf bank_mask:0xf
    v_add_f32_dpp v19, v19, v19 row_ror:4 row_mask:0xf bank_mask:0xf
    s_waitcnt vmcnt(12)
    v_mfma_f32_16x16x32_bf16 v[40:43], v[62:65], v[72:75], 0
    v_add_f32_dpp v20, v20, v20 row_ror:4 row_mask:0xf bank_mask:0xf
    v_add_f32_dpp v21, v21, v21 row_ror:4 row_mask:0xf bank_mask:0xf
    v_mfma_f32_16x16x32_bf16 v[44:47], v[60:63], v[72:75], 0
    v_add_f32_dpp v22, v22, v22 row_ror:4 row_mask:0xf bank_mask:0xf
    v_add_f32_dpp v23, v23, v23 row_ror:4 row_mask:0xf bank_mask:0xf
    v_mfma_f32_16x16x32_bf16 v[48:51], v[62:65], v[76:79], 0
    v_add_f32_dpp v16, v16, v16 row_ror:8 row_mask:0xf bank_mask:0xf
    v_add_f32_dpp v17, v17, v17 row_ror:8 row_mask:0xf bank_mask:0xf
    v_mfma_f32_16x16x32_bf16 v[52:55], v[60:63], v[76:79], 0
    v_add_f32_dpp v18, v18, v18 row_ror:8 row_mask:0xf bank_mask:0xf
    v_add_f32_dpp v19, v19, v19 row_ror:8 row_mask:0xf bank_mask:0xf
    v_add_f32_dpp v20, v20, v20 row_ror:8 row_mask:0xf bank_mask:0xf
    v_add_f32_dpp v21, v21, v21 row_ror:8 row_mask:0xf bank_mask:0xf
    v_add_f32_dpp v22, v22, v22 row_ror:8 row_mask:0xf bank_mask:0xf
    v_add_f32_dpp v23, v23, v23 row_ror:8 row_mask:0xf bank_mask:0xf
    s_waitcnt vmcnt(10)
    v_mfma_f32_16x16x32_bf16 v[40:43], v[62:65], v[80:83], v[40:43]
    v_mov_b32 v24, v16
    v_mov_b32 v25, v17
    v_mfma_f32_16x16x32_bf16 v[44:47], v[60:63], v[80:83], v[44:47]
    v_mov_b32 v26, v18
    v_mov_b32 v27, v19
    v_mfma_f32_16x16x32_bf16 v[48:51], v[62:65], v[84:87], v[48:51]
    v_mov_b32 v28, v20
    v_mov_b32 v29, v21
    v_mfma_f32_16x16x32_bf16 v[52:55], v[60:63], v[84:87], v[52:55]
    v_mov_b32 v30, v22
    v_mov_b32 v31, v23
    v_permlane16_swap_b32 v16, v24
    v_permlane16_swap_b32 v17, v25
    v_permlane16_swap_b32 v18, v26
    v_permlane16_swap_b32 v19, v27
    s_waitcnt vmcnt(8)
    v_mfma_f32_16x16x32_bf16 v[40:43], v[62:65], v[88:91], v[40:43]
    v_permlane16_swap_b32 v20, v28
    v_permlane16_swap_b32 v21, v29
    v_mfma_f32_16x16x32_bf16 v[44:47], v[60:63], v[88:91], v[44:47]
    v_permlane16_swap_b32 v22, v30
    v_permlane16_swap_b32 v23, v31
    v_mfma_f32_16x16x32_bf16 v[48:51], v[62:65], v[92:95], v[48:51]
    v_add_f32 v16, v16, v24
    v_add_f32 v17, v17, v25
    v_mfma_f32_16x16x32_bf16 v[52:55], v[60:63], v[92:95], v[52:55]
    v_add_f32 v18, v18, v26
    v_add_f32 v19, v19, v27
    v_add_f32 v20, v20, v28
    v_add_f32 v21, v21, v29
    v_add_f32 v22, v22, v30
    v_add_f32 v23, v23, v31
    s_waitcnt vmcnt(6)
    v_mfma_f32_16x16x32_bf16 v[40:43], v[62:65], v[96:99], v[40:43]
    v_mov_b32 v24, v16
    v_mov_b32 v25, v17
    v_mfma_f32_16x16x32_bf16 v[44:47], v[60:63], v[96:99], v[44:47]
    v_mov_b32 v26, v18
    v_mov_b32 v27, v19
    v_mfma_f32_16x16x32_bf16 v[48:51], v[62:65], v[100:103], v[48:51]
    v_mov_b32 v28, v20
    v_mov_b32 v29, v21
    v_mfma_f32_16x16x32_bf16 v[52:55], v[60:63], v[100:103], v[52:55]
    v_mov_b32 v30, v22
    v_mov_b32 v31, v23
    v_permlane32_swap_b32 v16, v24
    v_permlane32_swap_b32 v17, v25
    v_permlane32_swap_b32 v18, v26
    v_permlane32_swap_b32 v19, v27
    s_waitcnt vmcnt(4)
    v_mfma_f32_16x16x32_bf16 v[40:43], v[62:65], v[104:107], v[40:43]
    v_permlane32_swap_b32 v20, v28
    v_permlane32_swap_b32 v21, v29
    v_mfma_f32_16x16x32_bf16 v[44:47], v[60:63], v[104:107], v[44:47]
    v_permlane32_swap_b32 v22, v30
    v_permlane32_swap_b32 v23, v31
    v_mfma_f32_16x16x32_bf16 v[48:51], v[62:65], v[108:111], v[48:51]
    v_add_f32 v16, v16, v24
    v_add_f32 v17, v17, v25
    v_mfma_f32_16x16x32_bf16 v[52:55], v[60:63], v[108:111], v[52:55]
    v_add_f32 v18, v18, v26
    v_add_f32 v19, v19, v27
    v_add_f32 v20, v20, v28
    v_add_f32 v21, v21, v29
    v_add_f32 v22, v22, v30
    v_add_f32 v23, v23, v31
    s_waitcnt vmcnt(2)
    v_mfma_f32_16x16x32_bf16 v[40:43], v[62:65], v[112:115], v[40:43]
    v_cvt_pk_bf16_f32 v16, v16, v17
    v_cvt_pk_bf16_f32 v17, v18, v19
    v_mfma_f32_16x16x32_bf16 v[44:47], v[60:63], v[112:115], v[44:47]
    v_cvt_pk_bf16_f32 v18, v20, v21
    v_cvt_pk_bf16_f32 v19, v22, v23
    v_mfma_f32_16x16x32_bf16 v[48:51], v[62:65], v[116:119], v[48:51]
    ds_bpermute_b32 v24, v6, v16
    ds_bpermute_b32 v25, v6, v17
    v_mfma_f32_16x16x32_bf16 v[52:55], v[60:63], v[116:119], v[52:55]
    ds_bpermute_b32 v26, v6, v18
    ds_bpermute_b32 v27, v6, v19
    s_waitcnt vmcnt(0)
    v_mfma_f32_16x16x32_bf16 v[40:43], v[62:65], v[120:123], v[40:43]
    v_mfma_f32_16x16x32_bf16 v[44:47], v[60:63], v[120:123], v[44:47]
    v_mfma_f32_16x16x32_bf16 v[48:51], v[62:65], v[124:127], v[48:51]
    v_mfma_f32_16x16x32_bf16 v[52:55], v[60:63], v[124:127], v[52:55]
    s_waitcnt lgkmcnt(0)
    v_mfma_f32_16x16x32_bf16 v[144:147], v[24:27], v[204:207], 0
    v_mfma_f32_16x16x32_bf16 v[156:159], v[24:27], v[208:211], 0
    v_mfma_f32_16x16x32_bf16 v[168:171], v[24:27], v[212:215], 0
    v_mfma_f32_16x16x32_bf16 v[180:183], v[24:27], v[216:219], 0
    v_mfma_f32_16x16x32_bf16 v[192:195], v[24:27], v[220:223], 0
    s_nop 2
    v_cvt_pk_bf16_f32 v16, v40, v41
    v_cvt_pk_bf16_f32 v17, v42, v43
    v_cvt_pk_bf16_f32 v18, v44, v45
    v_cvt_pk_bf16_f32 v19, v46, v47
    v_cvt_pk_bf16_f32 v20, v48, v49
    v_cvt_pk_bf16_f32 v21, v50, v51
    v_cvt_pk_bf16_f32 v22, v52, v53
    v_cvt_pk_bf16_f32 v23, v54, v55
    ds_write_b128 v3, v[16:19]
    ds_write_b128 v3, v[20:23] offset:1024
    ds_write_b32 v9, v10 offset:16
    v_mfma_f32_16x16x32_bf16 v[136:139], v[16:19], v[204:207], 0
    v_add_f32 v144, s36, v144
    v_mfma_f32_16x16x32_bf16 v[140:143], v[20:23], v[204:207], 0
    v_rcp_f32 v144, v144
    v_mfma_f32_16x16x32_bf16 v[148:151], v[16:19], v[208:211], 0
    v_add_f32 v156, s36, v156
    v_mfma_f32_16x16x32_bf16 v[152:155], v[20:23], v[208:211], 0
    v_rcp_f32 v156, v156
    v_mfma_f32_16x16x32_bf16 v[160:163], v[16:19], v[212:215], 0
    v_add_f32 v168, s36, v168
    v_mfma_f32_16x16x32_bf16 v[164:167], v[20:23], v[212:215], 0
    v_rcp_f32 v168, v168
    v_mfma_f32_16x16x32_bf16 v[172:175], v[16:19], v[216:219], 0
    v_add_f32 v180, s36, v180
    v_mfma_f32_16x16x32_bf16 v[176:179], v[20:23], v[216:219], 0
    v_rcp_f32 v180, v180
    v_mfma_f32_16x16x32_bf16 v[184:187], v[16:19], v[220:223], 0
    v_add_f32 v192, s36, v192
    v_mfma_f32_16x16x32_bf16 v[188:191], v[20:23], v[220:223], 0
    v_rcp_f32 v192, v192
    s_mov_b32 s39, 1048576
LW_11:
    ds_read_b32 v5, v8 offset:16
    s_waitcnt lgkmcnt(0)
    v_cmp_eq_u32 vcc, 0, v5
    s_cbranch_vccz LE_12
    s_sub_u32 s39, s39, 1
    s_cbranch_scc0 LW_11
LE_12:
    ds_read_b128 v[72:75], v7
    ds_read_b128 v[76:79], v7 offset:1024
    v_mul_f32 v144, s34, v144
    v_mul_f32 v156, s34, v156
    v_mul_f32 v168, s34, v168
    v_mul_f32 v180, s34, v180
    v_mul_f32 v192, s34, v192
    s_waitcnt lgkmcnt(0)
    v_mfma_f32_16x16x32_bf16 v[136:139], v[72:75], v[204:207], v[136:139]
    v_mfma_f32_16x16x32_bf16 v[140:143], v[76:79], v[204:207], v[140:143]
    v_mfma_f32_16x16x32_bf16 v[148:151], v[72:75], v[208:211], v[148:151]
    v_mfma_f32_16x16x32_bf16 v[152:155], v[76:79], v[208:211], v[152:155]
    v_mfma_f32_16x16x32_bf16 v[160:163], v[72:75], v[212:215], v[160:163]
    v_mfma_f32_16x16x32_bf16 v[164:167], v[76:79], v[212:215], v[164:167]
    v_mfma_f32_16x16x32_bf16 v[172:175], v[72:75], v[216:219], v[172:175]
    v_mfma_f32_16x16x32_bf16 v[176:179], v[76:79], v[216:219], v[176:179]
    v_mfma_f32_16x16x32_bf16 v[184:187], v[72:75], v[220:223], v[184:187]
    v_mfma_f32_16x16x32_bf16 v[188:191], v[76:79], v[220:223], v[188:191]
    v_pk_mul_f32 v[136:137], v[136:137], v[144:145] op_sel_hi:[1,0]
    v_pk_mul_f32 v[138:139], v[138:139], v[144:145] op_sel_hi:[1,0]
    v_pk_mul_f32 v[140:141], v[140:141], v[144:145] op_sel_hi:[1,0]
    v_pk_mul_f32 v[142:143], v[142:143], v[144:145] op_sel_hi:[1,0]
    v_cvt_pk_bf16_f32 v80, v136, v137
    v_cvt_pk_bf16_f32 v81, v138, v139
    v_cvt_pk_bf16_f32 v82, v140, v141
    v_cvt_pk_bf16_f32 v83, v142, v143
    s_lshr_b32 s30, s48, 3
    s_lshl_b32 s30, s30, 18
    s_and_b32 s31, s48, 7
    s_lshl_b32 s31, s31, 10
    s_add_u32 s30, s30, s31
    s_add_u32 s30, s30, s49
    s_add_u32 s48, s48, 1
    buffer_store_dwordx4 v[80:83], v2, s[44:47], s30 offen sc1
    s_add_u32 s30, s30, 32768
    v_pk_mul_f32 v[148:149], v[148:149], v[156:157] op_sel_hi:[1,0]
    v_pk_mul_f32 v[150:151], v[150:151], v[156:157] op_sel_hi:[1,0]
    v_pk_mul_f32 v[152:153], v[152:153], v[156:157] op_sel_hi:[1,0]
    v_pk_mul_f32 v[154:155], v[154:155], v[156:157] op_sel_hi:[1,0]
    v_cvt_pk_bf16_f32 v84, v148, v149
    v_cvt_pk_bf16_f32 v85, v150, v151
    v_cvt_pk_bf16_f32 v86, v152, v153
    v_cvt_pk_bf16_f32 v87, v154, v155
    s_lshr_b32 s30, s48, 3
    s_lshl_b32 s30, s30, 18
    s_and_b32 s31, s48, 7
    s_lshl_b32 s31, s31, 10
    s_add_u32 s30, s30, s31
    s_add_u32 s30, s30, s49
    s_add_u32 s48, s48, 1
    buffer_store_dwordx4 v[84:87], v2, s[44:47], s30 offen sc1
    s_add_u32 s30, s30, 32768
    v_pk_mul_f32 v[160:161], v[160:161], v[168:169] op_sel_hi:[1,0]
    v_pk_mul_f32 v[162:163], v[162:163], v[168:169] op_sel_hi:[1,0]
    v_pk_mul_f32 v[164:165], v[164:165], v[168:169] op_sel_hi:[1,0]
    v_pk_mul_f32 v[166:167], v[166:167], v[168:169] op_sel_hi:[1,0]
    v_cvt_pk_bf16_f32 v88, v160, v161
    v_cvt_pk_bf16_f32 v89, v162, v163
    v_cvt_pk_bf16_f32 v90, v164, v165
    v_cvt_pk_bf16_f32 v91, v166, v167
    s_lshr_b32 s30, s48, 3
    s_lshl_b32 s30, s30, 18
    s_and_b32 s31, s48, 7
    s_lshl_b32 s31, s31, 10
    s_add_u32 s30, s30, s31
    s_add_u32 s30, s30, s49
    s_add_u32 s48, s48, 1
    buffer_store_dwordx4 v[88:91], v2, s[44:47], s30 offen sc1
    s_add_u32 s30, s30, 32768
    v_pk_mul_f32 v[172:173], v[172:173], v[180:181] op_sel_hi:[1,0]
    v_pk_mul_f32 v[174:175], v[174:175], v[180:181] op_sel_hi:[1,0]
    v_pk_mul_f32 v[176:177], v[176:177], v[180:181] op_sel_hi:[1,0]
    v_pk_mul_f32 v[178:179], v[178:179], v[180:181] op_sel_hi:[1,0]
    v_cvt_pk_bf16_f32 v92, v172, v173
    v_cvt_pk_bf16_f32 v93, v174, v175
    v_cvt_pk_bf16_f32 v94, v176, v177
    v_cvt_pk_bf16_f32 v95, v178, v179
    s_lshr_b32 s30, s48, 3
    s_lshl_b32 s30, s30, 18
    s_and_b32 s31, s48, 7
    s_lshl_b32 s31, s31, 10
    s_add_u32 s30, s30, s31
    s_add_u32 s30, s30, s49
    s_add_u32 s48, s48, 1
    buffer_store_dwordx4 v[92:95], v2, s[44:47], s30 offen sc1
    s_add_u32 s30, s30, 32768
    v_pk_mul_f32 v[184:185], v[184:185], v[192:193] op_sel_hi:[1,0]
    v_pk_mul_f32 v[186:187], v[186:187], v[192:193] op_sel_hi:[1,0]
    v_pk_mul_f32 v[188:189], v[188:189], v[192:193] op_sel_hi:[1,0]
    v_pk_mul_f32 v[190:191], v[190:191], v[192:193] op_sel_hi:[1,0]
    v_cvt_pk_bf16_f32 v96, v184, v185
    v_cvt_pk_bf16_f32 v97, v186, v187
    v_cvt_pk_bf16_f32 v98, v188, v189
    v_cvt_pk_bf16_f32 v99, v190, v191
    s_lshr_b32 s30, s48, 3
    s_lshl_b32 s30, s30, 18
    s_and_b32 s31, s48, 7
    s_lshl_b32 s31, s31, 10
    s_add_u32 s30, s30, s31
    s_add_u32 s30, s30, s49
    s_add_u32 s48, s48, 1
    buffer_store_dwordx4 v[96:99], v2, s[44:47], s30 offen sc1
    s_add_u32 s30, s30, 32768
    s_mul_i32 s30, s37, 5
    s_add_u32 s31, s30, 4
    s_min_u32 s31, s31, 127
    s_lshr_b32 s30, s30, 3
    s_lshr_b32 s31, s31, 3
    s_cmp_eq_u32 s30, s31
    s_cselect_b64 s[60:61], 1, 3
    s_lshl_b32 s30, s30, 9
    s_lshr_b32 s31, s23, 2
    s_lshl_b32 s31, s31, 7
    s_add_u32 s30, s30, s31
    s_add_u32 s30, s30, 0x5b1000
    v_lshlrev_b32 v6, 9, v0
    ds_write_b32 v4, v10 offset:40
    v_mov_b32 v5, 1
    s_mov_b64 exec, s[60:61]
    s_waitcnt vmcnt(0)
    buffer_atomic_add v5, v6, s[16:19], s30 offen sc1
    s_mov_b64 exec, -1
    s_setprio 0
    s_branch L_y1b
L_wo:
    s_mov_b32 s44, s84
    s_and_b32 s45, s85, 0xffff
    s_mov_b32 s46, 0x200000
    s_mov_b32 s47, 0x20000
    s_sub_u32 s26, s25, 4
    v_lshrrev_b32 v1, 3, v0
    v_and_b32 v4, 7, v0
    v_lshrrev_b32 v5, 4, v0
    v_lshlrev_b32 v3, 11, v1
    v_lshlrev_b32 v6, 1, v5
    v_xor_b32 v6, v4, v6
    v_lshlrev_b32 v6, 4, v6
    v_add_u32 v3, v3, v6
    s_lshl_b32 s30, s29, 7
    v_add_u32 v40, s30, v3
    v_mov_b32 v41, 137280
    v_mov_b32 v42, 1
    s_cmp_eq_u32 s57, 1
    s_cbranch_scc1 L_13
    s_waitcnt vmcnt(22)
    s_barrier
L_13:
    s_mul_i32 s35, s26, 2
    s_add_u32 s35, s35, 18
    s_lshl_b32 s37, s35, 16
    s_lshl_b32 s35, s35, 12
    s_mov_b32 s31, 0
L_14:
    s_mov_b32 m0, s35
    s_add_u32 s35, s35, 1024
    buffer_load_dwordx4 v40, s[44:47], s37 offen lds
    s_add_u32 s37, s37, 16384
    s_mov_b32 m0, s35
    s_add_u32 s35, s35, 1024
    buffer_load_dwordx4 v40, s[44:47], s37 offen lds
    s_add_u32 s37, s37, 16384
    s_mov_b32 m0, s35
    s_add_u32 s35, s35, 1024
    buffer_load_dwordx4 v40, s[44:47], s37 offen lds
    s_add_u32 s37, s37, 16384
    s_mov_b32 m0, s35
    s_add_u32 s35, s35, 1024
    buffer_load_dwordx4 v40, s[44:47], s37 offen lds
    s_add_u32 s37, s37, 16384
    s_waitcnt vmcnt(40)
    s_add_u32 s31, s31, 1
    s_cmp_lt_u32 s31, 2
    s_cbranch_scc1 L_14
    s_cmp_eq_u32 s57, 1
    s_cbranch_scc1 L_15
    s_waitcnt vmcnt(8)
    s_barrier
L_15:
    s_mul_i32 s35, s26, 1
    s_add_u32 s35, s35, 30
    s_lshl_b32 s37, s35, 16
    s_lshl_b32 s35, s35, 12
    s_mov_b32 s31, 0
L_16:
    s_mov_b32 m0, s35
    s_add_u32 s35, s35, 1024
    buffer_load_dwordx4 v40, s[44:47], s37 offen lds
    s_add_u32 s37, s37, 16384
    s_mov_b32 m0, s35
    s_add_u32 s35, s35, 1024
    buffer_load_dwordx4 v40, s[44:47], s37 offen lds
    s_add_u32 s37, s37, 16384
    s_mov_b32 m0, s35
    s_add_u32 s35, s35, 1024
    buffer_load_dwordx4 v40, s[44:47], s37 offen lds
    s_add_u32 s37, s37, 16384
    s_mov_b32 m0, s35
    s_add_u32 s35, s35, 1024
    buffer_load_dwordx4 v40, s[44:47], s37 offen lds
    s_add_u32 s37, s37, 16384
    s_waitcnt vmcnt(40)
    s_add_u32 s31, s31, 1
    s_cmp_lt_u32 s31, 1
    s_cbranch_scc1 L_16
    s_cmp_eq_u32 s57, 1
    s_cbranch_scc1 L_17
    s_nop 0
    s_barrier
L_17:
    s_mul_i32 s35, s26, 2
    s_add_u32 s35, s35, 7
    s_lshl_b32 s37, s35, 16
    s_lshl_b32 s35, s35, 12
    s_mov_b32 s31, 0
L_18:
    s_mov_b32 m0, s35
    s_add_u32 s35, s35, 1024
    buffer_load_dwordx4 v40, s[44:47], s37 offen lds
    s_add_u32 s37, s37, 16384
    s_mov_b32 m0, s35
    s_add_u32 s35, s35, 1024
    buffer_load_dwordx4 v40, s[44:47], s37 offen lds
    s_add_u32 s37, s37, 16384
    s_mov_b32 m0, s35
    s_add_u32 s35, s35, 1024
    buffer_load_dwordx4 v40, s[44:47], s37 offen lds
    s_add_u32 s37, s37, 16384
    s_mov_b32 m0, s35
    s_add_u32 s35, s35, 1024
    buffer_load_dwordx4 v40, s[44:47], s37 offen lds
    s_add_u32 s37, s37, 16384
    s_waitcnt vmcnt(40)
    s_add_u32 s31, s31, 1
    s_cmp_lt_u32 s31, 2
    s_cbranch_scc1 L_18
    s_cmp_eq_u32 s26, 0
    s_cbranch_scc1 L_wo9
    s_cmp_eq_u32 s57, 1
    s_cbranch_scc1 L_wo8
    s_mov_b32 s39, 1048576
L_wo7:
    ds_read_b32 v43, v41 offset:48
    s_waitcnt lgkmcnt(0)
    v_cmp_gt_u32 vcc, 4, v43
    s_cbranch_vccz L_wo8
    s_sleep 1
    s_sub_u32 s39, s39, 1
    s_cbranch_scc0 L_wo7
L_wo8:
    s_mul_i32 s35, s26, 0
    s_add_u32 s35, s35, 0
    s_lshl_b32 s37, s35, 16
    s_lshl_b32 s35, s35, 12
    s_mov_b32 s31, 0
L_19:
    s_mov_b32 m0, s35
    s_add_u32 s35, s35, 1024
    buffer_load_dwordx4 v40, s[44:47], s37 offen lds
    s_add_u32 s37, s37, 16384
    s_mov_b32 m0, s35
    s_add_u32 s35, s35, 1024
    buffer_load_dwordx4 v40, s[44:47], s37 offen lds
    s_add_u32 s37, s37, 16384
    s_mov_b32 m0, s35
    s_add_u32 s35, s35, 1024
    buffer_load_dwordx4 v40, s[44:47], s37 offen lds
    s_add_u32 s37, s37, 16384
    s_mov_b32 m0, s35
    s_add_u32 s35, s35, 1024
    buffer_load_dwordx4 v40, s[44:47], s37 offen lds
    s_add_u32 s37, s37, 16384
    s_waitcnt vmcnt(40)
    s_add_u32 s31, s31, 1
    s_cmp_lt_u32 s31, 7
    s_cbranch_scc1 L_19
    s_mul_i32 s35, s26, 0
    s_add_u32 s35, s35, 11
    s_lshl_b32 s37, s35, 16
    s_lshl_b32 s35, s35, 12
    s_mov_b32 s31, 0
L_20:
    s_mov_b32 m0, s35
    s_add_u32 s35, s35, 1024
    buffer_load_dwordx4 v40, s[44:47], s37 offen lds
    s_add_u32 s37, s37, 16384
    s_mov_b32 m0, s35
    s_add_u32 s35, s35, 1024
    buffer_load_dwordx4 v40, s[44:47], s37 offen lds
    s_add_u32 s37, s37, 16384
    s_mov_b32 m0, s35
    s_add_u32 s35, s35, 1024
    buffer_load_dwordx4 v40, s[44:47], s37 offen lds
    s_add_u32 s37, s37, 16384
    s_mov_b32 m0, s35
    s_add_u32 s35, s35, 1024
    buffer_load_dwordx4 v40, s[44:47], s37 offen lds
    s_add_u32 s37, s37, 16384
    s_waitcnt vmcnt(40)
    s_add_u32 s31, s31, 1
    s_cmp_lt_u32 s31, 7
    s_cbranch_scc1 L_20
    s_mul_i32 s35, s26, 0
    s_add_u32 s35, s35, 22
    s_lshl_b32 s37, s35, 16
    s_lshl_b32 s35, s35, 12
    s_mov_b32 s31, 0
L_21:
    s_mov_b32 m0, s35
    s_add_u32 s35, s35, 1024
    buffer_load_dwordx4 v40, s[44:47], s37 offen lds
    s_add_u32 s37, s37, 16384
    s_mov_b32 m0, s35
    s_add_u32 s35, s35, 1024
    buffer_load_dwordx4 v40, s[44:47], s37 offen lds
    s_add_u32 s37, s37, 16384
    s_mov_b32 m0, s35
    s_add_u32 s35, s35, 1024
    buffer_load_dwordx4 v40, s[44:47], s37 offen lds
    s_add_u32 s37, s37, 16384
    s_mov_b32 m0, s35
    s_add_u32 s35, s35, 1024
    buffer_load_dwordx4 v40, s[44:47], s37 offen lds
    s_add_u32 s37, s37, 16384
    s_waitcnt vmcnt(40)
    s_add_u32 s31, s31, 1
    s_cmp_lt_u32 s31, 8
    s_cbranch_scc1 L_21
    s_branch L_phase2
L_wo9:
    s_waitcnt vmcnt(0) lgkmcnt(0)
    s_cmp_lg_u32 s25, 4
    s_cbranch_scc1 L_phase2
    s_cmp_eq_u32 s57, 1
    s_cbranch_scc1 L_phase2
    v_mov_b32 v41, 137280
    v_lshlrev_b32 v5, 7, v0
    s_xor_b32 s30, s23, 1
    s_lshl_b32 s30, s30, 8
    s_add_u32 s30, s30, 0x5b0000
    s_setprio 0
    s_mov_b32 s39, 1048576
LW_22:
    ds_read_b32 v42, v41 offset:36
    s_waitcnt lgkmcnt(0)
    v_cmp_eq_u32 vcc, 0, v42
    s_cbranch_vccz LE_23
    s_sleep 1
    s_sub_u32 s39, s39, 1
    s_cbranch_scc0 LW_22
LE_23:
    s_mov_b64 exec, 3
    s_mov_b32 s39, 131072
LP_24:
    v_mov_b32 v7, 0
    buffer_atomic_add v7, v5, s[16:19], s30 offen sc0 sc1
    s_waitcnt vmcnt(0)
    v_cmp_gt_u32 vcc, 26, v7
    s_cbranch_vccz LD_25
    s_sleep 1
    s_sub_u32 s39, s39, 1
    s_cbranch_scc0 LP_24
LD_25:
    s_mov_b64 exec, -1
    v_mov_b32 v42, 1
    ds_write_b32 v41, v42 offset:32
    s_branch L_phase2
L_dryret:
    s_setpc_b64 s[62:63]
L_service:
    s_sub_u32 s26, s25, 6
    s_waitcnt lgkmcnt(0)
    s_mov_b32 s8, s4
    s_and_b32 s9, s5, 0xffff
    s_mov_b32 s12, s6
    s_and_b32 s13, s7, 0xffff
    s_mov_b32 s16, s82
    s_and_b32 s17, s83, 0xffff
    s_mov_b32 s30, 0x5a8000
    s_load_dword s52, s[82:83], s30
    s_cmp_eq_u32 s57, 1
    s_cbranch_scc1 L_moe_w
    s_mov_b32 s40, s84
    s_and_b32 s41, s85, 0xffff
    s_mov_b32 s42, 0x200000
    s_mov_b32 s43, 0x20000
    v_mov_b32 v4, 137280
    v_mov_b32 v8, 0
    v_mov_b32 v9, 0
    v_mov_b32 v10, 0
    v_mov_b32 v11, 0
    ds_write_b128 v4, v[8:11]
    ds_write_b128 v4, v[8:11] offset:16
    ds_write_b128 v4, v[8:11] offset:32
    ds_write_b128 v4, v[8:11] offset:48
    s_waitcnt lgkmcnt(0)
    s_add_u32 s52, s52, 1
    s_cmp_lg_u32 s26, 0
    s_cbranch_scc1 L_26
    s_mov_b64 exec, 0
    s_call_b64 s[62:63], L_d0
    s_mov_b64 exec, -1
    s_mov_b64 exec, 0
    s_call_b64 s[62:63], L_d1
    s_mov_b64 exec, -1
    s_branch L_27
L_26:
    s_mov_b64 exec, 0
    s_call_b64 s[62:63], L_d2
    s_mov_b64 exec, -1
    s_mov_b64 exec, 0
    s_call_b64 s[62:63], L_d3
    s_mov_b64 exec, -1
L_27:
    s_barrier
    s_cmp_lg_u32 s26, 0
    s_cbranch_scc1 L_28
    v_mov_b32 v6, 137216
    ds_read_b128 v[40:43], v6
    ds_read_b128 v[44:47], v6 offset:16
    s_lshl_b32 s30, s2, 7
    s_add_u32 s30, s30, 0x5b0000
    s_mov_b64 exec, 1
    buffer_store_dword v2, v2, s[16:19], s30 offen sc1
    s_mov_b64 exec, -1
    s_waitcnt lgkmcnt(0)
    v_max3_u32 v40, v40, v41, v42
    v_max3_u32 v40, v40, v43, v44
    v_max3_u32 v40, v40, v45, v46
    v_max_u32 v40, v40, v47
    v_mov_b32 v41, s52
L_28:
    s_cmp_lg_u32 s26, 1
    s_cbranch_scc1 L_29
    s_mul_i32 s30, s21, 24
    s_add_u32 s30, s30, 384
    v_add_u32 v4, s30, v0
    v_lshlrev_b32 v4, 11, v4
    v_cmp_gt_u32 vcc, 24, v0
    v_mov_b32 v5, 0x7ff00000
    s_lshr_b32 s31, s20, 1
    s_lshl_b32 s31, s31, 9
    s_add_u32 s31, s31, 384
    v_cndmask_b32 v4, v5, v4, vcc
    s_bitcmp1_b32 s20, 1
    s_cselect_b32 s31, 0x600000, s31
    buffer_load_dword v244, v4, s[12:15], s31 offen
L_29:
    s_barrier
    s_cmp_lg_u32 s26, 0
    s_cbranch_scc1 L_30
    s_lshl_b32 s30, s2, 3
    s_add_u32 s30, s30, 0x5a0000
    s_mov_b64 exec, 1
    s_waitcnt vmcnt(0)
    buffer_store_dwordx2 v[40:41], v2, s[16:19], s30 offen sc1
    s_mov_b64 exec, -1
    s_and_b32 s69, s69, 0xffff
    s_mov_b32 s70, 256
    s_mov_b32 s71, 0x20000
    s_and_b32 s30, s2, 3
    s_lshl_b32 s30, s30, 6
    v_mov_b32 v5, 1
    s_mov_b64 exec, 1
    buffer_atomic_add v5, v2, s[68:71], s30 offen sc1
    s_mov_b64 exec, -1
L_30:
    s_barrier
    s_cmp_lg_u32 s26, 1
    s_cbranch_scc1 L_31
    s_mul_i32 s30, s21, 24
    s_add_u32 s30, s30, 960
    v_add_u32 v4, s30, v0
    v_lshlrev_b32 v4, 11, v4
    v_cmp_gt_u32 vcc, 24, v0
    v_mov_b32 v5, 0x7ff00000
    s_lshr_b32 s31, s20, 1
    s_lshl_b32 s31, s31, 9
    s_add_u32 s31, s31, 384
    v_cndmask_b32 v4, v5, v4, vcc
    s_bitcmp1_b32 s20, 1
    s_cselect_b32 s31, 0x600000, s31
    buffer_load_dword v244, v4, s[12:15], s31 offen
L_31:
    s_barrier
    s_barrier
    s_barrier
    s_cmp_lg_u32 s26, 1
    s_cbranch_scc1 L_32
    s_mul_i32 s30, s21, 24
    s_add_u32 s30, s30, 1536
    v_add_u32 v4, s30, v0
    v_lshlrev_b32 v4, 11, v4
    v_cmp_gt_u32 vcc, 24, v0
    v_mov_b32 v5, 0x7ff00000
    s_lshr_b32 s31, s20, 1
    s_lshl_b32 s31, s31, 9
    s_add_u32 s31, s31, 384
    v_cndmask_b32 v4, v5, v4, vcc
    s_bitcmp1_b32 s20, 1
    s_cselect_b32 s31, 0x600000, s31
    buffer_load_dword v244, v4, s[12:15], s31 offen
L_32:
    s_barrier
    s_barrier
    s_barrier
    s_cmp_lg_u32 s26, 1
    s_cbranch_scc1 L_33
    s_mul_i32 s30, s21, 24
    s_add_u32 s30, s30, 2112
    v_add_u32 v4, s30, v0
    v_lshlrev_b32 v4, 11, v4
    v_cmp_gt_u32 vcc, 24, v0
    v_mov_b32 v5, 0x7ff00000
    s_lshr_b32 s31, s20, 1
    s_lshl_b32 s31, s31, 9
    s_add_u32 s31, s31, 384
    v_cndmask_b32 v4, v5, v4, vcc
    s_bitcmp1_b32 s20, 1
    s_cselect_b32 s31, 0x600000, s31
    buffer_load_dword v244, v4, s[12:15], s31 offen
L_33:
    s_barrier
    v_lshlrev_b32 v19, 5, v0
    s_mov_b32 s54, 0x5a0000
    buffer_load_dwordx4 v[40:43], v19, s[16:19], s54 offen sc1
    buffer_load_dwordx4 v[44:47], v19, s[16:19], s54 offen offset:16 sc1
    s_mov_b32 s60, 10
    s_mov_b32 s61, 0
L_sloop:
    s_barrier
    s_cmp_eq_u32 s61, 5
    s_cbranch_scc1 L_snext
    s_cmp_eq_u32 s61, 0
    s_cbranch_scc1 L_s0
    s_add_u32 s61, s61, 1
    s_cmp_eq_u32 s61, 2
    s_cbranch_scc1 L_snext
    s_cmp_eq_u32 s61, 3
    s_cbranch_scc1 L_s2
    s_cmp_eq_u32 s61, 4
    s_cbranch_scc1 L_s3
    s_cmp_lg_u32 s26, 1
    s_cbranch_scc1 L_34
    v_mov_b32 v20, v64
    v_mov_b32 v21, v65
    v_mov_b32 v22, v66
    v_mov_b32 v23, v67
    v_mov_b32 v24, v80
    v_mov_b32 v25, v81
    v_mov_b32 v26, v82
    v_mov_b32 v27, v83
    v_mov_b32 v28, v96
    v_mov_b32 v29, v97
    v_mov_b32 v30, v98
    v_mov_b32 v31, v99
    v_permlane32_swap_b32 v64, v20
    v_permlane32_swap_b32 v65, v21
    v_permlane32_swap_b32 v66, v22
    v_permlane32_swap_b32 v67, v23
    v_permlane32_swap_b32 v80, v24
    v_permlane32_swap_b32 v81, v25
    v_permlane32_swap_b32 v82, v26
    v_permlane32_swap_b32 v83, v27
    v_permlane32_swap_b32 v96, v28
    v_permlane32_swap_b32 v97, v29
    v_permlane32_swap_b32 v98, v30
    v_permlane32_swap_b32 v99, v31
    v_add_f32 v64, v64, v20
    v_add_f32 v65, v65, v21
    v_add_f32 v66, v66, v22
    v_add_f32 v67, v67, v23
    v_add_f32 v80, v80, v24
    v_add_f32 v81, v81, v25
    v_add_f32 v82, v82, v26
    v_add_f32 v83, v83, v27
    v_add_f32 v96, v96, v28
    v_add_f32 v97, v97, v29
    v_add_f32 v98, v98, v30
    v_add_f32 v99, v99, v31
    v_bfe_u32 v4, v0, 3, 1
    v_lshlrev_b32 v4, 7, v4
    v_and_b32 v5, 7, v0
    v_lshlrev_b32 v5, 2, v5
    v_add_u32 v4, v4, v5
    v_add_u32 v4, 136448, v4
    ds_write_b32 v4, v64 offset:0
    ds_write_b32 v4, v65 offset:32
    ds_write_b32 v4, v66 offset:64
    ds_write_b32 v4, v67 offset:96
    ds_write_b32 v4, v80 offset:256
    ds_write_b32 v4, v81 offset:288
    ds_write_b32 v4, v82 offset:320
    ds_write_b32 v4, v83 offset:352
    ds_write_b32 v4, v96 offset:512
    ds_write_b32 v4, v97 offset:544
    ds_write_b32 v4, v98 offset:576
    ds_write_b32 v4, v99 offset:608
L_34:
    s_waitcnt lgkmcnt(0)
    s_branch L_snext
L_s3:
    s_cmp_lg_u32 s26, 0
    s_cbranch_scc1 L_35
    v_lshlrev_b32 v4, 3, v0
    v_add_u32 v4, 137344, v4
    ds_write_b64 v4, v[48:49]
    ds_write_b64 v4, v[52:53] offset:512
    v_cvt_pk_bf16_f32 v58, v58, v58
    v_and_b32 v58, 0xffff0000, v58
    v_mul_f32 v58, 0xbfb8aa3b, v58
    v_exp_f32 v58, v58
    s_nop 0
    v_add_f32 v58, 1.0, v58
    v_rcp_f32 v58, v58
    s_nop 0
    v_cvt_pk_bf16_f32 v58, v58, v58
    v_and_b32 v58, 0xffff0000, v58
    v_mov_b32 v59, s55
    v_mov_b32 v4, 137248
    ds_write_b64 v4, v[58:59]
    s_branch L_36
L_35:
    v_mov_b32 v20, v64
    v_mov_b32 v21, v65
    v_mov_b32 v22, v66
    v_mov_b32 v23, v67
    v_mov_b32 v24, v80
    v_mov_b32 v25, v81
    v_mov_b32 v26, v82
    v_mov_b32 v27, v83
    v_mov_b32 v28, v96
    v_mov_b32 v29, v97
    v_mov_b32 v30, v98
    v_mov_b32 v31, v99
    v_permlane16_swap_b32 v64, v20
    v_permlane16_swap_b32 v65, v21
    v_permlane16_swap_b32 v66, v22
    v_permlane16_swap_b32 v67, v23
    v_permlane16_swap_b32 v80, v24
    v_permlane16_swap_b32 v81, v25
    v_permlane16_swap_b32 v82, v26
    v_permlane16_swap_b32 v83, v27
    v_permlane16_swap_b32 v96, v28
    v_permlane16_swap_b32 v97, v29
    v_permlane16_swap_b32 v98, v30
    v_permlane16_swap_b32 v99, v31
    v_add_f32 v64, v64, v20
    v_add_f32 v65, v65, v21
    v_add_f32 v66, v66, v22
    v_add_f32 v67, v67, v23
    v_add_f32 v80, v80, v24
    v_add_f32 v81, v81, v25
    v_add_f32 v82, v82, v26
    v_add_f32 v83, v83, v27
    v_add_f32 v96, v96, v28
    v_add_f32 v97, v97, v29
    v_add_f32 v98, v98, v30
    v_add_f32 v99, v99, v31
L_36:
    s_branch L_snext
L_s2:
    s_waitcnt vmcnt(0)
    s_cmp_lg_u32 s26, 0
    s_cbranch_scc1 L_37
    v_mul_f32 v21, 0x3fb8aa3b, v21
    v_mul_f32 v23, 0x3fb8aa3b, v23
    v_mul_f32 v25, 0x3fb8aa3b, v25
    v_mul_f32 v20, v20, v21
    v_mul_f32 v22, v22, v23
    v_mul_f32 v24, v24, v25
    v_lshlrev_b32 v4, 2, v0
    v_add_u32 v4, 135168, v4
    ds_write_b32 v4, v21
    ds_write_b32 v4, v23 offset:256
    ds_write_b32 v4, v20 offset:640
    ds_write_b32 v4, v22 offset:896
    s_mov_b32 exec_hi, 0
    ds_write_b32 v4, v25 offset:512
    ds_write_b32 v4, v24 offset:1152
    s_mov_b64 exec, -1
L_37:
    s_branch L_snext
L_s0:
    s_mov_b32 s39, 131072
L_s0l:
    s_waitcnt vmcnt(0)
    v_xor_b32 v4, s52, v41
    v_xor_b32 v5, s52, v43
    v_xor_b32 v6, s52, v45
    v_xor_b32 v7, s52, v47
    v_or_b32 v4, v4, v5
    v_or3_b32 v4, v4, v6, v7
    v_cmp_ne_u32 vcc, 0, v4
    s_cbranch_vccz L_s0k
    buffer_load_dwordx4 v[40:43], v19, s[16:19], s54 offen sc1
    buffer_load_dwordx4 v[44:47], v19, s[16:19], s54 offen offset:16 sc1
    s_cmp_lt_u32 s60, 11
    s_cbranch_scc1 L_snext
    s_sleep 8
    s_sub_u32 s39, s39, 1
    s_cbranch_scc0 L_s0l
    s_waitcnt vmcnt(0)
L_s0k:
    s_cmp_lg_u32 s26, 0
    s_cbranch_scc1 L_38
    v_max_u32 v40, v40, v42
    v_max3_u32 v40, v40, v44, v46
    s_nop 1
    s_nop 1
    v_max_u32_dpp v40, v40, v40 quad_perm:[1,0,3,2] row_mask:0xf bank_mask:0xf
    s_nop 1
    v_max_u32_dpp v40, v40, v40 quad_perm:[2,3,0,1] row_mask:0xf bank_mask:0xf
    s_nop 1
    v_max_u32_dpp v40, v40, v40 row_half_mirror row_mask:0xf bank_mask:0xf
    s_nop 1
    v_max_u32_dpp v40, v40, v40 row_mirror row_mask:0xf bank_mask:0xf
    v_mov_b32 v41, v40
    s_nop 1
    s_nop 0
    v_permlane16_swap_b32 v40, v41
    s_nop 0
    v_max_u32 v40, v40, v41
    v_mov_b32 v41, v40
    s_nop 1
    s_nop 0
    v_permlane32_swap_b32 v40, v41
    s_nop 0
    v_max_u32 v40, v40, v41
    s_nop 0
    v_readfirstlane_b32 s55, v40
    s_nop 3
    s_and_b32 s55, s55, 0x7ff
    s_sub_u32 s55, 2047, s55
    s_lshl_b32 s31, s28, 11
    s_add_u32 s31, s31, 0x510000
    buffer_load_dwordx4 v[48:51], v2, s[16:19], s31 offen sc1
    buffer_load_dwordx4 v[52:55], v2, s[16:19], s31 offen offset:1024 sc1
    s_lshl_b32 s30, s55, 4
    s_add_u32 s30, s30, 0x510000
    v_mov_b32 v4, 0
    buffer_load_dwordx4 v[56:59], v4, s[16:19], s30 offen sc1
    s_mul_i32 s30, s22, 2560
    s_add_u32 s30, s30, 0x510000
    buffer_load_dwordx2 v[20:21], v2, s[16:19], s30 offen sc1
    buffer_load_dwordx2 v[22:23], v2, s[16:19], s30 offen offset:1024 sc1
    buffer_load_dwordx2 v[24:25], v2, s[16:19], s30 offen offset:2048 sc1
    s_cmp_lg_u32 s2, 0
    s_cbranch_scc1 L_40
    s_mov_b32 s30, 0x5a8000
    v_mov_b32 v6, s52
    s_mov_b64 exec, 1
    buffer_store_dword v6, v4, s[16:19], s30 offen sc1
    s_mov_b64 exec, -1
L_40:
    s_branch L_39
L_38:
    v_lshrrev_b32 v4, 4, v0
    v_mul_u32_u24 v4, 12288, v4
    v_and_b32 v5, 15, v0
    v_lshlrev_b32 v5, 4, v5
    v_add_u32 v4, v4, v5
    s_lshl_b32 s30, s23, 8
    s_add_u32 s30, s30, 0x520000
    s_add_u32 s31, s30, 0
    s_xor_b32 s31, s31, 256
    buffer_load_dwordx4 v[64:67], v4, s[16:19], s31 offen sc1
    s_add_u32 s31, s30, 4096
    buffer_load_dwordx4 v[80:83], v4, s[16:19], s31 offen sc1
    s_add_u32 s31, s30, 8192
    buffer_load_dwordx4 v[96:99], v4, s[16:19], s31 offen sc1
L_39:
    s_mov_b32 s61, 1
L_snext:
    s_add_u32 s60, s60, 1
    s_cmp_lt_u32 s60, 17
    s_cbranch_scc1 L_sloop
    s_mov_b32 s44, s78
    s_and_b32 s45, s79, 0xffff
    s_mov_b32 s46, 0x700000
    s_mov_b32 s47, 0x20000
    s_lshr_b32 s50, s2, 4
    s_lshl_b32 s50, s50, 1
    s_add_u32 s50, s50, s25
    s_sub_u32 s50, s50, 6
    s_mul_i32 s51, s50, 14
    s_and_b32 s27, s2, 15
    v_lshrrev_b32 v1, 3, v0
    v_and_b32 v3, 7, v0
    v_lshlrev_b32 v3, 4, v3
    v_lshlrev_b32 v17, 11, v1
    v_add_u32 v17, v17, v3
    s_lshl_b32 s30, s51, 14
    s_lshl_b32 s31, s27, 7
    s_add_u32 s30, s30, s31
    buffer_load_dwordx4 v[64:67], v17, s[44:47], s30 offen nt
    s_add_u32 s30, s30, 16384
    buffer_load_dwordx4 v[68:71], v17, s[44:47], s30 offen nt
    s_add_u32 s30, s30, 16384
    buffer_load_dwordx4 v[72:75], v17, s[44:47], s30 offen nt
    s_add_u32 s30, s30, 16384
    buffer_load_dwordx4 v[76:79], v17, s[44:47], s30 offen nt
    s_add_u32 s30, s30, 16384
    buffer_load_dwordx4 v[80:83], v17, s[44:47], s30 offen nt
    s_add_u32 s30, s30, 16384
    buffer_load_dwordx4 v[84:87], v17, s[44:47], s30 offen nt
    s_add_u32 s30, s30, 16384
    buffer_load_dwordx4 v[88:91], v17, s[44:47], s30 offen nt
    s_add_u32 s30, s30, 16384
    buffer_load_dwordx4 v[92:95], v17, s[44:47], s30 offen nt
    s_add_u32 s30, s30, 16384
    buffer_load_dwordx4 v[96:99], v17, s[44:47], s30 offen nt
    s_add_u32 s30, s30, 16384
    buffer_load_dwordx4 v[100:103], v17, s[44:47], s30 offen nt
    s_add_u32 s30, s30, 16384
    buffer_load_dwordx4 v[104:107], v17, s[44:47], s30 offen nt
    s_add_u32 s30, s30, 16384
    buffer_load_dwordx4 v[108:111], v17, s[44:47], s30 offen nt
    s_add_u32 s30, s30, 16384
    buffer_load_dwordx4 v[112:115], v17, s[44:47], s30 offen nt
    s_add_u32 s30, s30, 16384
    buffer_load_dwordx4 v[116:119], v17, s[44:47], s30 offen nt
    s_add_u32 s30, s30, 16384
    v_mov_b32 v9, 0xffff
    v_and_b32 v8, 1, v0
    v_lshlrev_b32 v8, 4, v8
    v_lshlrev_b32 v8, v8, v9
    v_bfe_u32 v9, v0, 1, 2
    v_cmp_eq_u32 vcc, 0, v9
    s_nop 1
    v_cndmask_b32 v124, 0, v8, vcc
    v_cmp_eq_u32 vcc, 1, v9
    s_nop 1
    v_cndmask_b32 v125, 0, v8, vcc
    v_cmp_eq_u32 vcc, 2, v9
    s_nop 1
    v_cndmask_b32 v126, 0, v8, vcc
    v_cmp_eq_u32 vcc, 3, v9
    s_nop 1
    v_cndmask_b32 v127, 0, v8, vcc
    s_mov_b32 s40, s80
    s_and_b32 s41, s81, 0xffff
    s_mov_b32 s42, 0x400000
    s_mov_b32 s43, 0x20000
    s_lshl_b32 s71, s28, 3
    s_add_u32 s71, s71, s25
    s_lshl_b32 s56, s28, 18
    s_lshl_b32 s69, s25, 10
    s_add_u32 s56, s56, s69
    s_lshl_b32 s71, s71, 4
    v_and_b32 v247, 15, v0
    v_add_u32 v246, s71, v247
    v_lshlrev_b32 v246, 11, v246
    v_bfe_u32 v224, v0, 4, 1
    v_lshlrev_b32 v224, 5, v224
    v_lshrrev_b32 v225, 5, v0
    v_lshlrev_b32 v225, 4, v225
    v_add_u32 v224, v224, v225
    s_lshl_b32 s69, s29, 7
    v_add3_u32 v246, v246, v224, s69
    buffer_load_dwordx4 v[248:251], v246, s[8:11], 0 offen
    buffer_load_dwordx4 v[252:255], v246, s[8:11], 0 offen offset:64
    s_and_b32 s71, s71, 127
    v_add_u32 v247, s71, v247
    v_lshlrev_b32 v224, 3, v247
    v_add_u32 v224, 137344, v224
    v_mov_b32 v225, 137248
    ds_read_b64 v[240:241], v224
    ds_read_b64 v[242:243], v225
    v_lshrrev_b32 v245, 4, v0
    v_lshlrev_b32 v245, 4, v245
    s_waitcnt vmcnt(0) lgkmcnt(0)
    v_readfirstlane_b32 s55, v243
    v_mov_b32 v244, v241
    v_permlane16_swap_b32 v248, v250
    v_permlane16_swap_b32 v249, v251
    v_permlane16_swap_b32 v252, v254
    v_permlane16_swap_b32 v253, v255
    v_lshlrev_b32 v224, 16, v248
    v_and_b32 v225, 0xffff0000, v248
    v_add_f32 v248, v224, v240
    v_add_f32 v243, v225, v240
    v_cvt_pk_bf16_f32 v248, v248, v243
    v_and_b32 v243, 0xffff0000, v248
    v_lshlrev_b32 v248, 16, v248
    v_mul_f32 v248, v248, v244
    v_mul_f32 v243, v243, v244
    v_cvt_pk_bf16_f32 v248, v248, v243
    v_and_b32 v243, 0xffff0000, v248
    v_lshlrev_b32 v248, 16, v248
    v_add_f32 v224, v224, v248
    v_add_f32 v225, v225, v243
    v_lshlrev_b32 v226, 16, v249
    v_and_b32 v227, 0xffff0000, v249
    v_add_f32 v249, v226, v240
    v_add_f32 v243, v227, v240
    v_cvt_pk_bf16_f32 v249, v249, v243
    v_and_b32 v243, 0xffff0000, v249
    v_lshlrev_b32 v249, 16, v249
    v_mul_f32 v249, v249, v244
    v_mul_f32 v243, v243, v244
    v_cvt_pk_bf16_f32 v249, v249, v243
    v_and_b32 v243, 0xffff0000, v249
    v_lshlrev_b32 v249, 16, v249
    v_add_f32 v226, v226, v249
    v_add_f32 v227, v227, v243
    v_lshlrev_b32 v228, 16, v250
    v_and_b32 v229, 0xffff0000, v250
    v_add_f32 v250, v228, v240
    v_add_f32 v243, v229, v240
    v_cvt_pk_bf16_f32 v250, v250, v243
    v_and_b32 v243, 0xffff0000, v250
    v_lshlrev_b32 v250, 16, v250
    v_mul_f32 v250, v250, v244
    v_mul_f32 v243, v243, v244
    v_cvt_pk_bf16_f32 v250, v250, v243
    v_and_b32 v243, 0xffff0000, v250
    v_lshlrev_b32 v250, 16, v250
    v_add_f32 v228, v228, v250
    v_add_f32 v229, v229, v243
    v_lshlrev_b32 v230, 16, v251
    v_and_b32 v231, 0xffff0000, v251
    v_add_f32 v251, v230, v240
    v_add_f32 v243, v231, v240
    v_cvt_pk_bf16_f32 v251, v251, v243
    v_and_b32 v243, 0xffff0000, v251
    v_lshlrev_b32 v251, 16, v251
    v_mul_f32 v251, v251, v244
    v_mul_f32 v243, v243, v244
    v_cvt_pk_bf16_f32 v251, v251, v243
    v_and_b32 v243, 0xffff0000, v251
    v_lshlrev_b32 v251, 16, v251
    v_add_f32 v230, v230, v251
    v_add_f32 v231, v231, v243
    v_lshlrev_b32 v232, 16, v252
    v_and_b32 v233, 0xffff0000, v252
    v_add_f32 v252, v232, v240
    v_add_f32 v243, v233, v240
    v_cvt_pk_bf16_f32 v252, v252, v243
    v_and_b32 v243, 0xffff0000, v252
    v_lshlrev_b32 v252, 16, v252
    v_mul_f32 v252, v252, v244
    v_mul_f32 v243, v243, v244
    v_cvt_pk_bf16_f32 v252, v252, v243
    v_and_b32 v243, 0xffff0000, v252
    v_lshlrev_b32 v252, 16, v252
    v_add_f32 v232, v232, v252
    v_add_f32 v233, v233, v243
    v_lshlrev_b32 v234, 16, v253
    v_and_b32 v235, 0xffff0000, v253
    v_add_f32 v253, v234, v240
    v_add_f32 v243, v235, v240
    v_cvt_pk_bf16_f32 v253, v253, v243
    v_and_b32 v243, 0xffff0000, v253
    v_lshlrev_b32 v253, 16, v253
    v_mul_f32 v253, v253, v244
    v_mul_f32 v243, v243, v244
    v_cvt_pk_bf16_f32 v253, v253, v243
    v_and_b32 v243, 0xffff0000, v253
    v_lshlrev_b32 v253, 16, v253
    v_add_f32 v234, v234, v253
    v_add_f32 v235, v235, v243
    v_lshlrev_b32 v236, 16, v254
    v_and_b32 v237, 0xffff0000, v254
    v_add_f32 v254, v236, v240
    v_add_f32 v243, v237, v240
    v_cvt_pk_bf16_f32 v254, v254, v243
    v_and_b32 v243, 0xffff0000, v254
    v_lshlrev_b32 v254, 16, v254
    v_mul_f32 v254, v254, v244
    v_mul_f32 v243, v243, v244
    v_cvt_pk_bf16_f32 v254, v254, v243
    v_and_b32 v243, 0xffff0000, v254
    v_lshlrev_b32 v254, 16, v254
    v_add_f32 v236, v236, v254
    v_add_f32 v237, v237, v243
    v_lshlrev_b32 v238, 16, v255
    v_and_b32 v239, 0xffff0000, v255
    v_add_f32 v255, v238, v240
    v_add_f32 v243, v239, v240
    v_cvt_pk_bf16_f32 v255, v255, v243
    v_and_b32 v243, 0xffff0000, v255
    v_lshlrev_b32 v255, 16, v255
    v_mul_f32 v255, v255, v244
    v_mul_f32 v243, v243, v244
    v_cvt_pk_bf16_f32 v255, v255, v243
    v_and_b32 v243, 0xffff0000, v255
    v_lshlrev_b32 v255, 16, v255
    v_add_f32 v238, v238, v255
    v_add_f32 v239, v239, v243
    v_and_b32 v248, 60, v0
    v_lshlrev_b32 v248, 5, v248
    v_bfe_u32 v249, v0, 3, 2
    v_lshlrev_b32 v249, 5, v249
    v_add_u32 v248, v248, v249
    v_and_b32 v249, 3, v0
    v_lshlrev_b32 v249, 3, v249
    v_add_u32 v248, v248, v249
    v_xor_b32 v249, 32, v248
    v_xor_b32 v250, 64, v248
    v_xor_b32 v251, 96, v248
    v_add_u32 v252, 0x10000, v248
    v_add_u32 v253, 0x10000, v249
    v_add_u32 v254, 0x10000, v250
    v_add_u32 v255, 0x10000, v251
    s_branch L_down
L_moe_k:
    s_waitcnt lgkmcnt(0)
    s_mov_b32 s8, s4
    s_and_b32 s9, s5, 0xffff
    s_mov_b32 s12, s6
    s_and_b32 s13, s7, 0xffff
    s_mov_b32 s16, s82
    s_and_b32 s17, s83, 0xffff
L_moe_w:
    v_lshrrev_b32 v1, 3, v0
    v_mul_u32_u24 v3, 6144, v1
    v_and_b32 v4, 7, v0
    v_lshlrev_b32 v4, 4, v4
    v_add_u32 v3, v3, v4
    s_and_b32 s30, s58, 3
    s_lshl_b32 s30, s30, 1
    s_lshr_b32 s31, s25, 2
    s_add_u32 s30, s30, s31
    s_mul_i32 s30, s30, 49152
    s_and_b32 s31, s58, 0xfc
    s_and_b32 s32, s25, 3
    s_add_u32 s31, s31, s32
    s_lshl_b32 s31, s31, 7
    s_add_u32 s30, s30, s31
    buffer_load_dwordx4 v[128:131], v3, s[12:15], s30 offen
    s_add_u32 s30, s30, 393216
    buffer_load_dwordx4 v[132:135], v3, s[12:15], s30 offen
    s_add_u32 s30, s30, 393216
    buffer_load_dwordx4 v[136:139], v3, s[12:15], s30 offen
    s_add_u32 s30, s30, 393216
    buffer_load_dwordx4 v[140:143], v3, s[12:15], s30 offen
    s_add_u32 s30, s30, 393216
    buffer_load_dwordx4 v[144:147], v3, s[12:15], s30 offen
    s_add_u32 s30, s30, 393216
    buffer_load_dwordx4 v[148:151], v3, s[12:15], s30 offen
    s_add_u32 s30, s30, 393216
    buffer_load_dwordx4 v[152:155], v3, s[12:15], s30 offen
    s_add_u32 s30, s30, 393216
    buffer_load_dwordx4 v[156:159], v3, s[12:15], s30 offen
    s_add_u32 s30, s30, 393216
    buffer_load_dwordx4 v[160:163], v3, s[12:15], s30 offen
    s_add_u32 s30, s30, 393216
    buffer_load_dwordx4 v[164:167], v3, s[12:15], s30 offen
    s_add_u32 s30, s30, 393216
    buffer_load_dwordx4 v[168:171], v3, s[12:15], s30 offen
    s_add_u32 s30, s30, 393216
    buffer_load_dwordx4 v[172:175], v3, s[12:15], s30 offen
    s_add_u32 s30, s30, 393216
    buffer_load_dwordx4 v[176:179], v3, s[12:15], s30 offen
    s_add_u32 s30, s30, 393216
    buffer_load_dwordx4 v[180:183], v3, s[12:15], s30 offen
    s_add_u32 s30, s30, 393216
    buffer_load_dwordx4 v[184:187], v3, s[12:15], s30 offen
    s_add_u32 s30, s30, 393216
    buffer_load_dwordx4 v[188:191], v3, s[12:15], s30 offen
    s_add_u32 s30, s30, 393216
    s_cmp_lt_u32 s25, 4
    s_cbranch_scc1 L_crest
L_moe_a:
    s_setprio 0
    v_mov_b32 v121, 0x3f80
    v_and_b32 v120, 1, v0
    v_lshlrev_b32 v120, 4, v120
    v_lshlrev_b32 v120, v120, v121
    v_bfe_u32 v121, v0, 1, 2
    v_cmp_eq_u32 vcc, 0, v121
    s_nop 1
    v_cndmask_b32 v124, 0, v120, vcc
    v_cmp_eq_u32 vcc, 1, v121
    s_nop 1
    v_cndmask_b32 v125, 0, v120, vcc
    v_cmp_eq_u32 vcc, 2, v121
    s_nop 1
    v_cndmask_b32 v126, 0, v120, vcc
    v_cmp_eq_u32 vcc, 3, v121
    s_nop 1
    v_cndmask_b32 v127, 0, v120, vcc
    s_lshl_b32 s30, s25, 10
    s_add_u32 s30, s30, 147456
    v_add_u32 v1, s30, v2
    s_waitcnt vmcnt(0)
    v_mfma_f32_16x16x32_bf16 v[24:27], v[128:131], v[124:127], 0
    v_mfma_f32_16x16x32_bf16 v[24:27], v[132:135], v[124:127], v[24:27]
    v_mfma_f32_16x16x32_bf16 v[24:27], v[136:139], v[124:127], v[24:27]
    v_mfma_f32_16x16x32_bf16 v[24:27], v[140:143], v[124:127], v[24:27]
    v_mfma_f32_16x16x32_bf16 v[24:27], v[144:147], v[124:127], v[24:27]
    v_mfma_f32_16x16x32_bf16 v[24:27], v[148:151], v[124:127], v[24:27]
    v_mfma_f32_16x16x32_bf16 v[24:27], v[152:155], v[124:127], v[24:27]
    v_mfma_f32_16x16x32_bf16 v[24:27], v[156:159], v[124:127], v[24:27]
    v_mfma_f32_16x16x32_bf16 v[24:27], v[160:163], v[124:127], v[24:27]
    v_mfma_f32_16x16x32_bf16 v[24:27], v[164:167], v[124:127], v[24:27]
    v_mfma_f32_16x16x32_bf16 v[24:27], v[168:171], v[124:127], v[24:27]
    v_mfma_f32_16x16x32_bf16 v[24:27], v[172:175], v[124:127], v[24:27]
    v_mfma_f32_16x16x32_bf16 v[24:27], v[176:179], v[124:127], v[24:27]
    v_mfma_f32_16x16x32_bf16 v[24:27], v[180:183], v[124:127], v[24:27]
    v_mfma_f32_16x16x32_bf16 v[24:27], v[184:187], v[124:127], v[24:27]
    v_mfma_f32_16x16x32_bf16 v[24:27], v[188:191], v[124:127], v[24:27]
    s_nop 7
    ds_write_b128 v1, v[24:27]
    s_waitcnt lgkmcnt(0)
    s_add_u32 s52, s52, 1
    s_barrier
    s_and_b32 s48, s58, 1
    s_lshr_b32 s49, s58, 4
    s_lshr_b32 s50, s58, 1
    s_cmp_eq_u32 s48, 0
    s_cselect_b32 s40, s74, s76
    s_cselect_b32 s41, s75, s77
    s_and_b32 s41, s41, 0xffff
    s_mov_b32 s42, 7340032
    s_mov_b32 s43, 0x20000
    v_lshrrev_b32 v1, 3, v0
    v_and_b32 v3, 7, v0
    v_lshlrev_b32 v3, 4, v3
    s_cmp_eq_u32 s25, 7
    s_cbranch_scc1 L_moe7
    v_mul_u32_u24 v16, 7168, v1
    v_add_u32 v16, v16, v3
    s_and_b32 s27, s50, 7
    s_mul_i32 s27, s27, 7
    s_add_u32 s27, s27, s25
    s_mul_i32 s53, s49, 2465792
    s_lshl_b32 s30, s27, 7
    s_add_u32 s53, s53, s30
    s_mov_b32 s44, s84
    s_and_b32 s45, s85, 0xffff
    s_mov_b32 s46, 0x200000
    s_mov_b32 s47, 0x20000
    s_mul_i32 s30, s58, 7
    s_add_u32 s30, s30, s25
    s_mul_i32 s30, s30, 6272
    v_lshlrev_b32 v4, 7, v0
    s_mov_b32 exec_hi, 0x1ffff
    buffer_load_dword v244, v4, s[44:47], s30 offen
    s_mov_b64 exec, -1
    buffer_load_dwordx4 v[64:67], v16, s[40:43], s53 offen nt
    s_add_u32 s53, s53, 57344
    buffer_load_dwordx4 v[68:71], v16, s[40:43], s53 offen nt
    s_add_u32 s53, s53, 57344
    buffer_load_dwordx4 v[72:75], v16, s[40:43], s53 offen nt
    s_add_u32 s53, s53, 57344
    buffer_load_dwordx4 v[76:79], v16, s[40:43], s53 offen nt
    s_add_u32 s53, s53, 57344
    buffer_load_dwordx4 v[80:83], v16, s[40:43], s53 offen nt
    s_add_u32 s53, s53, 57344
    buffer_load_dwordx4 v[84:87], v16, s[40:43], s53 offen nt
    s_add_u32 s53, s53, 57344
    buffer_load_dwordx4 v[88:91], v16, s[40:43], s53 offen nt
    s_add_u32 s53, s53, 57344
    buffer_load_dwordx4 v[92:95], v16, s[40:43], s53 offen nt
    s_add_u32 s53, s53, 57344
    buffer_load_dwordx4 v[96:99], v16, s[40:43], s53 offen nt
    s_add_u32 s53, s53, 57344
    buffer_load_dwordx4 v[100:103], v16, s[40:43], s53 offen nt
    s_add_u32 s53, s53, 57344
    buffer_load_dwordx4 v[104:107], v16, s[40:43], s53 offen nt
    s_add_u32 s53, s53, 57344
    buffer_load_dwordx4 v[108:111], v16, s[40:43], s53 offen nt
    s_add_u32 s53, s53, 57344
    buffer_load_dwordx4 v[112:115], v16, s[40:43], s53 offen nt
    s_add_u32 s53, s53, 57344
    buffer_load_dwordx4 v[116:119], v16, s[40:43], s53 offen nt
    s_add_u32 s53, s53, 57344
    buffer_load_dwordx4 v[120:123], v16, s[40:43], s53 offen nt
    s_add_u32 s53, s53, 57344
    buffer_load_dwordx4 v[124:127], v16, s[40:43], s53 offen nt
    s_add_u32 s53, s53, 57344
    buffer_load_dwordx4 v[128:131], v16, s[40:43], s53 offen nt
    s_add_u32 s53, s53, 57344
    buffer_load_dwordx4 v[132:135], v16, s[40:43], s53 offen nt
    s_add_u32 s53, s53, 57344
    buffer_load_dwordx4 v[136:139], v16, s[40:43], s53 offen nt
    s_add_u32 s53, s53, 57344
    buffer_load_dwordx4 v[140:143], v16, s[40:43], s53 offen nt
    s_add_u32 s53, s53, 57344
    buffer_load_dwordx4 v[144:147], v16, s[40:43], s53 offen nt
    s_add_u32 s53, s53, 57344
    buffer_load_dwordx4 v[148:151], v16, s[40:43], s53 offen nt
    s_add_u32 s53, s53, 57344
    buffer_load_dwordx4 v[152:155], v16, s[40:43], s53 offen nt
    s_add_u32 s53, s53, 57344
    buffer_load_dwordx4 v[156:159], v16, s[40:43], s53 offen nt
    s_add_u32 s53, s53, 57344
    buffer_load_dwordx4 v[160:163], v16, s[40:43], s53 offen nt
    s_add_u32 s53, s53, 57344
    buffer_load_dwordx4 v[164:167], v16, s[40:43], s53 offen nt
    s_add_u32 s53, s53, 57344
    buffer_load_dwordx4 v[168:171], v16, s[40:43], s53 offen nt
    s_add_u32 s53, s53, 57344
    buffer_load_dwordx4 v[172:175], v16, s[40:43], s53 offen nt
    s_add_u32 s53, s53, 57344
    buffer_load_dwordx4 v[176:179], v16, s[40:43], s53 offen nt
    s_add_u32 s53, s53, 57344
    buffer_load_dwordx4 v[180:183], v16, s[40:43], s53 offen nt
    s_add_u32 s53, s53, 57344
    buffer_load_dwordx4 v[184:187], v16, s[40:43], s53 offen nt
    s_add_u32 s53, s53, 57344
    buffer_load_dwordx4 v[188:191], v16, s[40:43], s53 offen nt
    s_add_u32 s53, s53, 57344
    buffer_load_dwordx4 v[192:195], v16, s[40:43], s53 offen nt
    s_add_u32 s53, s53, 57344
    buffer_load_dwordx4 v[196:199], v16, s[40:43], s53 offen nt
    s_add_u32 s53, s53, 57344
    buffer_load_dwordx4 v[200:203], v16, s[40:43], s53 offen nt
    s_add_u32 s53, s53, 57344
    buffer_load_dwordx4 v[204:207], v16, s[40:43], s53 offen nt
    s_add_u32 s53, s53, 57344
    buffer_load_dwordx4 v[208:211], v16, s[40:43], s53 offen nt
    s_add_u32 s53, s53, 57344
    buffer_load_dwordx4 v[212:215], v16, s[40:43], s53 offen nt
    s_add_u32 s53, s53, 57344
    buffer_load_dwordx4 v[216:219], v16, s[40:43], s53 offen nt
    s_add_u32 s53, s53, 57344
    buffer_load_dwordx4 v[220:223], v16, s[40:43], s53 offen nt
    s_add_u32 s53, s53, 57344
    buffer_load_dwordx4 v[224:227], v16, s[40:43], s53 offen nt
    s_add_u32 s53, s53, 57344
    buffer_load_dwordx4 v[228:231], v16, s[40:43], s53 offen nt
    s_add_u32 s53, s53, 57344
    buffer_load_dwordx4 v[232:235], v16, s[40:43], s53 offen nt
    s_add_u32 s53, s53, 57344
    v_mov_b32 v9, 0xffff
    v_and_b32 v8, 1, v0
    v_lshlrev_b32 v8, 4, v8
    v_lshlrev_b32 v8, v8, v9
    v_bfe_u32 v9, v0, 1, 2
    v_cmp_eq_u32 vcc, 0, v9
    s_nop 1
    v_cndmask_b32 v240, 0, v8, vcc
    v_cmp_eq_u32 vcc, 1, v9
    s_nop 1
    v_cndmask_b32 v241, 0, v8, vcc
    v_cmp_eq_u32 vcc, 2, v9
    s_nop 1
    v_cndmask_b32 v242, 0, v8, vcc
    v_cmp_eq_u32 vcc, 3, v9
    s_nop 1
    v_cndmask_b32 v243, 0, v8, vcc
    v_mul_u32_u24 v17, 176, v1
    v_add_u32 v17, 139264, v17
    s_barrier
    ds_read_b128 v[20:23], v17 offset:0
    ds_read_b128 v[24:27], v17 offset:16
    ds_read_b128 v[28:31], v17 offset:32
    ds_read_b128 v[32:35], v17 offset:48
    ds_read_b128 v[36:39], v17 offset:64
    ds_read_b128 v[40:43], v17 offset:80
    ds_read_b128 v[44:47], v17 offset:96
    ds_read_b128 v[48:51], v17 offset:112
    ds_read_b128 v[52:55], v17 offset:128
    ds_read_b128 v[56:59], v17 offset:144
    ds_read_b128 v[60:63], v17 offset:160
    s_waitcnt lgkmcnt(0)
    v_and_b32 v12, v20, v240
    v_and_b32 v13, v20, v241
    v_and_b32 v14, v20, v242
    v_and_b32 v15, v20, v243
    s_waitcnt vmcnt(42)
    s_nop 0
    v_mfma_f32_16x16x32_bf16 v[8:11], v[64:67], v[12:15], 0
    v_and_b32 v16, v21, v240
    v_and_b32 v17, v21, v241
    v_and_b32 v18, v21, v242
    v_and_b32 v19, v21, v243
    s_waitcnt vmcnt(41)
    s_nop 0
    v_mfma_f32_16x16x32_bf16 v[8:11], v[68:71], v[16:19], v[8:11]
    v_and_b32 v12, v22, v240
    v_and_b32 v13, v22, v241
    v_and_b32 v14, v22, v242
    v_and_b32 v15, v22, v243
    s_waitcnt vmcnt(40)
    s_nop 0
    v_mfma_f32_16x16x32_bf16 v[8:11], v[72:75], v[12:15], v[8:11]
    v_and_b32 v16, v23, v240
    v_and_b32 v17, v23, v241
    v_and_b32 v18, v23, v242
    v_and_b32 v19, v23, v243
    s_waitcnt vmcnt(39)
    s_nop 0
    v_mfma_f32_16x16x32_bf16 v[8:11], v[76:79], v[16:19], v[8:11]
    v_and_b32 v12, v24, v240
    v_and_b32 v13, v24, v241
    v_and_b32 v14, v24, v242
    v_and_b32 v15, v24, v243
    s_waitcnt vmcnt(38)
    s_nop 0
    v_mfma_f32_16x16x32_bf16 v[8:11], v[80:83], v[12:15], v[8:11]
    v_and_b32 v16, v25, v240
    v_and_b32 v17, v25, v241
    v_and_b32 v18, v25, v242
    v_and_b32 v19, v25, v243
    s_waitcnt vmcnt(37)
    s_nop 0
    v_mfma_f32_16x16x32_bf16 v[8:11], v[84:87], v[16:19], v[8:11]
    v_and_b32 v12, v26, v240
    v_and_b32 v13, v26, v241
    v_and_b32 v14, v26, v242
    v_and_b32 v15, v26, v243
    s_waitcnt vmcnt(36)
    s_nop 0
    v_mfma_f32_16x16x32_bf16 v[8:11], v[88:91], v[12:15], v[8:11]
    v_and_b32 v16, v27, v240
    v_and_b32 v17, v27, v241
    v_and_b32 v18, v27, v242
    v_and_b32 v19, v27, v243
    s_waitcnt vmcnt(35)
    s_nop 0
    v_mfma_f32_16x16x32_bf16 v[8:11], v[92:95], v[16:19], v[8:11]
    v_and_b32 v12, v28, v240
    v_and_b32 v13, v28, v241
    v_and_b32 v14, v28, v242
    v_and_b32 v15, v28, v243
    s_waitcnt vmcnt(34)
    s_nop 0
    v_mfma_f32_16x16x32_bf16 v[8:11], v[96:99], v[12:15], v[8:11]
    v_and_b32 v16, v29, v240
    v_and_b32 v17, v29, v241
    v_and_b32 v18, v29, v242
    v_and_b32 v19, v29, v243
    s_waitcnt vmcnt(33)
    s_nop 0
    v_mfma_f32_16x16x32_bf16 v[8:11], v[100:103], v[16:19], v[8:11]
    v_and_b32 v12, v30, v240
    v_and_b32 v13, v30, v241
    v_and_b32 v14, v30, v242
    v_and_b32 v15, v30, v243
    s_waitcnt vmcnt(32)
    s_nop 0
    v_mfma_f32_16x16x32_bf16 v[8:11], v[104:107], v[12:15], v[8:11]
    v_and_b32 v16, v31, v240
    v_and_b32 v17, v31, v241
    v_and_b32 v18, v31, v242
    v_and_b32 v19, v31, v243
    s_waitcnt vmcnt(31)
    s_nop 0
    v_mfma_f32_16x16x32_bf16 v[8:11], v[108:111], v[16:19], v[8:11]
    v_and_b32 v12, v32, v240
    v_and_b32 v13, v32, v241
    v_and_b32 v14, v32, v242
    v_and_b32 v15, v32, v243
    s_waitcnt vmcnt(30)
    s_nop 0
    v_mfma_f32_16x16x32_bf16 v[8:11], v[112:115], v[12:15], v[8:11]
    v_and_b32 v16, v33, v240
    v_and_b32 v17, v33, v241
    v_and_b32 v18, v33, v242
    v_and_b32 v19, v33, v243
    s_waitcnt vmcnt(29)
    s_nop 0
    v_mfma_f32_16x16x32_bf16 v[8:11], v[116:119], v[16:19], v[8:11]
    v_and_b32 v12, v34, v240
    v_and_b32 v13, v34, v241
    v_and_b32 v14, v34, v242
    v_and_b32 v15, v34, v243
    s_waitcnt vmcnt(28)
    s_nop 0
    v_mfma_f32_16x16x32_bf16 v[8:11], v[120:123], v[12:15], v[8:11]
    v_and_b32 v16, v35, v240
    v_and_b32 v17, v35, v241
    v_and_b32 v18, v35, v242
    v_and_b32 v19, v35, v243
    s_waitcnt vmcnt(27)
    s_nop 0
    v_mfma_f32_16x16x32_bf16 v[8:11], v[124:127], v[16:19], v[8:11]
    v_and_b32 v12, v36, v240
    v_and_b32 v13, v36, v241
    v_and_b32 v14, v36, v242
    v_and_b32 v15, v36, v243
    s_waitcnt vmcnt(26)
    s_nop 0
    v_mfma_f32_16x16x32_bf16 v[8:11], v[128:131], v[12:15], v[8:11]
    v_and_b32 v16, v37, v240
    v_and_b32 v17, v37, v241
    v_and_b32 v18, v37, v242
    v_and_b32 v19, v37, v243
    s_waitcnt vmcnt(25)
    s_nop 0
    v_mfma_f32_16x16x32_bf16 v[8:11], v[132:135], v[16:19], v[8:11]
    v_and_b32 v12, v38, v240
    v_and_b32 v13, v38, v241
    v_and_b32 v14, v38, v242
    v_and_b32 v15, v38, v243
    s_waitcnt vmcnt(24)
    s_nop 0
    v_mfma_f32_16x16x32_bf16 v[8:11], v[136:139], v[12:15], v[8:11]
    v_and_b32 v16, v39, v240
    v_and_b32 v17, v39, v241
    v_and_b32 v18, v39, v242
    v_and_b32 v19, v39, v243
    s_waitcnt vmcnt(23)
    s_nop 0
    v_mfma_f32_16x16x32_bf16 v[8:11], v[140:143], v[16:19], v[8:11]
    v_and_b32 v12, v40, v240
    v_and_b32 v13, v40, v241
    v_and_b32 v14, v40, v242
    v_and_b32 v15, v40, v243
    s_waitcnt vmcnt(22)
    s_nop 0
    v_mfma_f32_16x16x32_bf16 v[8:11], v[144:147], v[12:15], v[8:11]
    v_and_b32 v16, v41, v240
    v_and_b32 v17, v41, v241
    v_and_b32 v18, v41, v242
    v_and_b32 v19, v41, v243
    s_waitcnt vmcnt(21)
    s_nop 0
    v_mfma_f32_16x16x32_bf16 v[8:11], v[148:151], v[16:19], v[8:11]
    v_and_b32 v12, v42, v240
    v_and_b32 v13, v42, v241
    v_and_b32 v14, v42, v242
    v_and_b32 v15, v42, v243
    s_waitcnt vmcnt(20)
    s_nop 0
    v_mfma_f32_16x16x32_bf16 v[8:11], v[152:155], v[12:15], v[8:11]
    v_and_b32 v16, v43, v240
    v_and_b32 v17, v43, v241
    v_and_b32 v18, v43, v242
    v_and_b32 v19, v43, v243
    s_waitcnt vmcnt(19)
    s_nop 0
    v_mfma_f32_16x16x32_bf16 v[8:11], v[156:159], v[16:19], v[8:11]
    v_and_b32 v12, v44, v240
    v_and_b32 v13, v44, v241
    v_and_b32 v14, v44, v242
    v_and_b32 v15, v44, v243
    s_waitcnt vmcnt(18)
    s_nop 0
    v_mfma_f32_16x16x32_bf16 v[8:11], v[160:163], v[12:15], v[8:11]
    v_and_b32 v16, v45, v240
    v_and_b32 v17, v45, v241
    v_and_b32 v18, v45, v242
    v_and_b32 v19, v45, v243
    s_waitcnt vmcnt(17)
    s_nop 0
    v_mfma_f32_16x16x32_bf16 v[8:11], v[164:167], v[16:19], v[8:11]
    v_and_b32 v12, v46, v240
    v_and_b32 v13, v46, v241
    v_and_b32 v14, v46, v242
    v_and_b32 v15, v46, v243
    s_waitcnt vmcnt(16)
    s_nop 0
    v_mfma_f32_16x16x32_bf16 v[8:11], v[168:171], v[12:15], v[8:11]
    v_and_b32 v16, v47, v240
    v_and_b32 v17, v47, v241
    v_and_b32 v18, v47, v242
    v_and_b32 v19, v47, v243
    s_waitcnt vmcnt(15)
    s_nop 0
    v_mfma_f32_16x16x32_bf16 v[8:11], v[172:175], v[16:19], v[8:11]
    v_and_b32 v12, v48, v240
    v_and_b32 v13, v48, v241
    v_and_b32 v14, v48, v242
    v_and_b32 v15, v48, v243
    s_waitcnt vmcnt(14)
    s_nop 0
    v_mfma_f32_16x16x32_bf16 v[8:11], v[176:179], v[12:15], v[8:11]
    v_and_b32 v16, v49, v240
    v_and_b32 v17, v49, v241
    v_and_b32 v18, v49, v242
    v_and_b32 v19, v49, v243
    s_waitcnt vmcnt(13)
    s_nop 0
    v_mfma_f32_16x16x32_bf16 v[8:11], v[180:183], v[16:19], v[8:11]
    v_and_b32 v12, v50, v240
    v_and_b32 v13, v50, v241
    v_and_b32 v14, v50, v242
    v_and_b32 v15, v50, v243
    s_waitcnt vmcnt(12)
    s_nop 0
    v_mfma_f32_16x16x32_bf16 v[8:11], v[184:187], v[12:15], v[8:11]
    v_and_b32 v16, v51, v240
    v_and_b32 v17, v51, v241
    v_and_b32 v18, v51, v242
    v_and_b32 v19, v51, v243
    s_waitcnt vmcnt(11)
    s_nop 0
    v_mfma_f32_16x16x32_bf16 v[8:11], v[188:191], v[16:19], v[8:11]
    v_and_b32 v12, v52, v240
    v_and_b32 v13, v52, v241
    v_and_b32 v14, v52, v242
    v_and_b32 v15, v52, v243
    s_waitcnt vmcnt(10)
    s_nop 0
    v_mfma_f32_16x16x32_bf16 v[8:11], v[192:195], v[12:15], v[8:11]
    v_and_b32 v16, v53, v240
    v_and_b32 v17, v53, v241
    v_and_b32 v18, v53, v242
    v_and_b32 v19, v53, v243
    s_waitcnt vmcnt(9)
    s_nop 0
    v_mfma_f32_16x16x32_bf16 v[8:11], v[196:199], v[16:19], v[8:11]
    v_and_b32 v12, v54, v240
    v_and_b32 v13, v54, v241
    v_and_b32 v14, v54, v242
    v_and_b32 v15, v54, v243
    s_waitcnt vmcnt(8)
    s_nop 0
    v_mfma_f32_16x16x32_bf16 v[8:11], v[200:203], v[12:15], v[8:11]
    v_and_b32 v16, v55, v240
    v_and_b32 v17, v55, v241
    v_and_b32 v18, v55, v242
    v_and_b32 v19, v55, v243
    s_waitcnt vmcnt(7)
    s_nop 0
    v_mfma_f32_16x16x32_bf16 v[8:11], v[204:207], v[16:19], v[8:11]
    v_and_b32 v12, v56, v240
    v_and_b32 v13, v56, v241
    v_and_b32 v14, v56, v242
    v_and_b32 v15, v56, v243
    s_waitcnt vmcnt(6)
    s_nop 0
    v_mfma_f32_16x16x32_bf16 v[8:11], v[208:211], v[12:15], v[8:11]
    v_and_b32 v16, v57, v240
    v_and_b32 v17, v57, v241
    v_and_b32 v18, v57, v242
    v_and_b32 v19, v57, v243
    s_waitcnt vmcnt(5)
    s_nop 0
    v_mfma_f32_16x16x32_bf16 v[8:11], v[212:215], v[16:19], v[8:11]
    v_and_b32 v12, v58, v240
    v_and_b32 v13, v58, v241
    v_and_b32 v14, v58, v242
    v_and_b32 v15, v58, v243
    s_waitcnt vmcnt(4)
    s_nop 0
    v_mfma_f32_16x16x32_bf16 v[8:11], v[216:219], v[12:15], v[8:11]
    v_and_b32 v16, v59, v240
    v_and_b32 v17, v59, v241
    v_and_b32 v18, v59, v242
    v_and_b32 v19, v59, v243
    s_waitcnt vmcnt(3)
    s_nop 0
    v_mfma_f32_16x16x32_bf16 v[8:11], v[220:223], v[16:19], v[8:11]
    v_and_b32 v12, v60, v240
    v_and_b32 v13, v60, v241
    v_and_b32 v14, v60, v242
    v_and_b32 v15, v60, v243
    s_waitcnt vmcnt(2)
    s_nop 0
    v_mfma_f32_16x16x32_bf16 v[8:11], v[224:227], v[12:15], v[8:11]
    v_and_b32 v16, v61, v240
    v_and_b32 v17, v61, v241
    v_and_b32 v18, v61, v242
    v_and_b32 v19, v61, v243
    s_waitcnt vmcnt(1)
    s_nop 0
    v_mfma_f32_16x16x32_bf16 v[8:11], v[228:231], v[16:19], v[8:11]
    v_and_b32 v12, v62, v240
    v_and_b32 v13, v62, v241
    v_and_b32 v14, v62, v242
    v_and_b32 v15, v62, v243
    s_waitcnt vmcnt(0)
    s_nop 0
    v_mfma_f32_16x16x32_bf16 v[8:11], v[232:235], v[12:15], v[8:11]
    v_lshrrev_b32 v16, 4, v0
    v_lshlrev_b32 v16, 7, v16
    v_add_u32 v16, v16, v3
    s_nop 5
    v_mov_b32 v12, v8
    v_mov_b32 v13, v9
    v_mov_b32 v14, v10
    v_mov_b32 v15, v11
    v_permlane32_swap_b32 v8, v12
    v_permlane32_swap_b32 v9, v13
    v_permlane32_swap_b32 v10, v14
    v_permlane32_swap_b32 v11, v15
    v_add_f32_dpp v8, v12, v8 row_ror:8 row_mask:0xf bank_mask:0xf
    v_add_f32_dpp v9, v13, v9 row_ror:8 row_mask:0xf bank_mask:0xf
    v_add_f32_dpp v10, v14, v10 row_ror:8 row_mask:0xf bank_mask:0xf
    v_add_f32_dpp v11, v15, v11 row_ror:8 row_mask:0xf bank_mask:0xf
    s_mul_i32 s30, s49, 28672
    s_mul_i32 s31, s48, 14336
    s_add_u32 s30, s30, s31
    s_lshl_b32 s31, s27, 8
    s_add_u32 s30, s30, s31
    s_add_u32 s30, s30, 0x560000
    s_mov_b32 exec_lo, 0x00ff00ff
    s_mov_b32 exec_hi, 0
    buffer_store_dwordx4 v[8:11], v16, s[16:19], s30 offen sc1
    s_mov_b64 exec, -1
    s_lshl_b32 s30, s27, 7
    s_add_u32 s30, s30, 0x5b3000
    v_mov_b32 v5, 1
    s_mov_b64 exec, 1
    s_waitcnt vmcnt(0)
    buffer_atomic_add v5, v2, s[16:19], s30 offen sc1
    s_mov_b64 exec, -1
    s_branch L_moe_d
L_moe7:
    s_setprio 3
    v_mov_b32 v4, 137280
    v_mov_b32 v8, 0
    v_mov_b32 v9, 0
    v_mov_b32 v10, 0
    v_mov_b32 v11, 0
    ds_write_b128 v4, v[8:11]
    ds_write_b128 v4, v[8:11] offset:16
    ds_write_b128 v4, v[8:11] offset:32
    ds_write_b128 v4, v[8:11] offset:48
    v_lshrrev_b32 v4, 4, v0
    v_lshlrev_b32 v4, 10, v4
    v_bfe_u32 v5, v0, 3, 1
    v_lshlrev_b32 v5, 8, v5
    v_add_u32 v4, v4, v5
    v_and_b32 v5, 7, v0
    v_lshlrev_b32 v5, 4, v5
    v_add_u32 v4, v4, v5
    v_add_u32 v4, 147456, v4
    ds_read_b128 v[8:11], v4 offset:0
    ds_read_b128 v[12:15], v4 offset:640
    ds_read_b128 v[16:19], v4 offset:4096
    ds_read_b128 v[20:23], v4 offset:4736
    s_and_b32 s30, s58, 3
    s_mul_i32 s30, s30, 12288
    s_lshr_b32 s31, s58, 2
    s_lshl_b32 s31, s31, 10
    s_add_u32 s30, s30, s31
    s_add_u32 s30, s30, 0x520000
    s_waitcnt lgkmcnt(0)
    v_add_f32 v8, v8, v12
    v_add_f32 v9, v9, v13
    v_add_f32 v10, v10, v14
    v_add_f32 v11, v11, v15
    v_add_f32 v8, v8, v16
    v_add_f32 v9, v9, v17
    v_add_f32 v10, v10, v18
    v_add_f32 v11, v11, v19
    v_add_f32 v8, v8, v20
    v_add_f32 v9, v9, v21
    v_add_f32 v10, v10, v22
    v_add_f32 v11, v11, v23
    buffer_store_dwordx4 v[8:11], v2, s[16:19], s30 offen sc1
    v_mov_b32 v6, 137216
    ds_read_b128 v[40:43], v6
    ds_read_b128 v[44:47], v6 offset:16
    s_lshl_b32 s30, s2, 7
    s_add_u32 s30, s30, 0x5b0000
    s_mov_b64 exec, 1
    buffer_store_dword v2, v2, s[16:19], s30 offen sc1
    s_mov_b64 exec, -1
    s_waitcnt lgkmcnt(0)
    v_max3_u32 v40, v40, v41, v42
    v_max3_u32 v40, v40, v43, v44
    v_max3_u32 v40, v40, v45, v46
    v_max_u32 v40, v40, v47
    v_mov_b32 v41, s52
    s_lshl_b32 s30, s2, 3
    s_add_u32 s30, s30, 0x5a0000
    s_mov_b64 exec, 1
    s_waitcnt vmcnt(0)
    buffer_store_dwordx2 v[40:41], v2, s[16:19], s30 offen sc1
    s_mov_b64 exec, -1
    s_and_b32 s69, s69, 0xffff
    s_mov_b32 s70, 256
    s_mov_b32 s71, 0x20000
    s_and_b32 s30, s2, 3
    s_lshl_b32 s30, s30, 6
    v_mov_b32 v5, 1
    s_mov_b64 exec, 1
    buffer_atomic_add v5, v2, s[68:71], s30 offen sc1
    s_mov_b64 exec, -1
    v_lshlrev_b32 v5, 6, v0
    s_mov_b32 s30, 0
    s_mov_b64 exec, 15
    s_mov_b32 s39, 131072
LP_41:
    v_mov_b32 v6, 0
    buffer_atomic_add v6, v5, s[68:71], s30 offen sc0 sc1
    s_waitcnt vmcnt(0)
    v_cmp_gt_u32 vcc, 64, v6
    s_cbranch_vccz LD_42
    s_sleep 8
    s_sub_u32 s39, s39, 1
    s_cbranch_scc0 LP_41
LD_42:
    s_mov_b64 exec, -1
    v_lshlrev_b32 v19, 5, v0
    s_mov_b32 s54, 0x5a0000
    buffer_load_dwordx4 v[40:43], v19, s[16:19], s54 offen sc1
    buffer_load_dwordx4 v[44:47], v19, s[16:19], s54 offen offset:16 sc1
    s_mov_b32 s39, 131072
L_43:
    s_waitcnt vmcnt(0)
    v_xor_b32 v4, s52, v41
    v_xor_b32 v5, s52, v43
    v_xor_b32 v6, s52, v45
    v_xor_b32 v7, s52, v47
    v_or_b32 v4, v4, v5
    v_or3_b32 v4, v4, v6, v7
    v_cmp_ne_u32 vcc, 0, v4
    s_cbranch_vccz L_44
    s_sleep 8
    buffer_load_dwordx4 v[40:43], v19, s[16:19], s54 offen sc1
    buffer_load_dwordx4 v[44:47], v19, s[16:19], s54 offen offset:16 sc1
    s_sub_u32 s39, s39, 1
    s_cbranch_scc0 L_43
L_44:
    s_waitcnt vmcnt(0)
    v_max_u32 v40, v40, v42
    v_max3_u32 v40, v40, v44, v46
    s_nop 1
    s_nop 1
    v_max_u32_dpp v40, v40, v40 quad_perm:[1,0,3,2] row_mask:0xf bank_mask:0xf
    s_nop 1
    v_max_u32_dpp v40, v40, v40 quad_perm:[2,3,0,1] row_mask:0xf bank_mask:0xf
    s_nop 1
    v_max_u32_dpp v40, v40, v40 row_half_mirror row_mask:0xf bank_mask:0xf
    s_nop 1
    v_max_u32_dpp v40, v40, v40 row_mirror row_mask:0xf bank_mask:0xf
    v_mov_b32 v41, v40
    s_nop 1
    s_nop 0
    v_permlane16_swap_b32 v40, v41
    s_nop 0
    v_max_u32 v40, v40, v41
    v_mov_b32 v41, v40
    s_nop 1
    s_nop 0
    v_permlane32_swap_b32 v40, v41
    s_nop 0
    v_max_u32 v40, v40, v41
    s_nop 0
    v_readfirstlane_b32 s55, v40
    s_nop 3
    s_and_b32 s55, s55, 0x7ff
    s_sub_u32 s55, 2047, s55
    s_lshl_b32 s31, s28, 11
    s_add_u32 s31, s31, 0x510000
    buffer_load_dwordx4 v[48:51], v2, s[16:19], s31 offen sc1
    buffer_load_dwordx4 v[52:55], v2, s[16:19], s31 offen offset:1024 sc1
    s_lshl_b32 s30, s55, 4
    s_add_u32 s30, s30, 0x510000
    v_mov_b32 v4, 0
    buffer_load_dwordx4 v[56:59], v4, s[16:19], s30 offen sc1
    s_lshl_b32 s30, s55, 11
    s_mul_i32 s31, s49, 688
    s_add_u32 s30, s30, s31
    buffer_load_dwordx4 v[20:23], v2, s[8:11], s30 offen
    s_waitcnt vmcnt(0)
    v_lshlrev_b32 v24, 16, v20
    v_and_b32 v25, 0xffff0000, v20
    v_lshlrev_b32 v26, 16, v21
    v_and_b32 v27, 0xffff0000, v21
    v_lshlrev_b32 v28, 16, v22
    v_and_b32 v29, 0xffff0000, v22
    v_lshlrev_b32 v30, 16, v23
    v_and_b32 v31, 0xffff0000, v23
    v_add_f32 v24, v24, v56
    v_add_f32 v25, v25, v56
    v_add_f32 v26, v26, v56
    v_add_f32 v27, v27, v56
    v_add_f32 v28, v28, v56
    v_add_f32 v29, v29, v56
    v_add_f32 v30, v30, v56
    v_add_f32 v31, v31, v56
    v_cvt_pk_bf16_f32 v24, v24, v24
    v_and_b32 v24, 0xffff0000, v24
    v_cvt_pk_bf16_f32 v25, v25, v25
    v_and_b32 v25, 0xffff0000, v25
    v_cvt_pk_bf16_f32 v26, v26, v26
    v_and_b32 v26, 0xffff0000, v26
    v_cvt_pk_bf16_f32 v27, v27, v27
    v_and_b32 v27, 0xffff0000, v27
    v_cvt_pk_bf16_f32 v28, v28, v28
    v_and_b32 v28, 0xffff0000, v28
    v_cvt_pk_bf16_f32 v29, v29, v29
    v_and_b32 v29, 0xffff0000, v29
    v_cvt_pk_bf16_f32 v30, v30, v30
    v_and_b32 v30, 0xffff0000, v30
    v_cvt_pk_bf16_f32 v31, v31, v31
    v_and_b32 v31, 0xffff0000, v31
    v_mul_f32 v24, v24, v57
    v_mul_f32 v25, v25, v57
    v_mul_f32 v26, v26, v57
    v_mul_f32 v27, v27, v57
    v_mul_f32 v28, v28, v57
    v_mul_f32 v29, v29, v57
    v_mul_f32 v30, v30, v57
    v_mul_f32 v31, v31, v57
    v_cvt_pk_bf16_f32 v24, v24, v24
    v_cvt_pk_bf16_f32 v25, v25, v25
    v_cvt_pk_bf16_f32 v26, v26, v26
    v_cvt_pk_bf16_f32 v27, v27, v27
    v_cvt_pk_bf16_f32 v28, v28, v28
    v_cvt_pk_bf16_f32 v29, v29, v29
    v_cvt_pk_bf16_f32 v30, v30, v30
    v_cvt_pk_bf16_f32 v31, v31, v31
    v_lshlrev_b32 v4, 2, v0
    v_add_u32 v4, 139264, v4
    s_mov_b32 exec_hi, 0xfff
    ds_write_b32 v4, v24 offset:0
    ds_write_b32 v4, v25 offset:176
    ds_write_b32 v4, v26 offset:352
    ds_write_b32 v4, v27 offset:528
    ds_write_b32 v4, v28 offset:704
    ds_write_b32 v4, v29 offset:880
    ds_write_b32 v4, v30 offset:1056
    ds_write_b32 v4, v31 offset:1232
    s_mov_b64 exec, -1
    v_lshlrev_b32 v4, 3, v0
    v_add_u32 v4, 137344, v4
    ds_write_b64 v4, v[48:49]
    ds_write_b64 v4, v[52:53] offset:512
    v_cvt_pk_bf16_f32 v58, v58, v58
    v_and_b32 v58, 0xffff0000, v58
    v_mul_f32 v58, 0xbfb8aa3b, v58
    v_exp_f32 v58, v58
    s_nop 0
    v_add_f32 v58, 1.0, v58
    v_rcp_f32 v58, v58
    s_nop 0
    v_cvt_pk_bf16_f32 v58, v58, v58
    v_and_b32 v58, 0xffff0000, v58
    v_mov_b32 v59, s55
    v_mov_b32 v4, 137248
    ds_write_b64 v4, v[58:59]
    v_mov_b32 v9, 0xffff
    v_and_b32 v8, 1, v0
    v_lshlrev_b32 v8, 4, v8
    v_lshlrev_b32 v8, v8, v9
    v_bfe_u32 v9, v0, 1, 2
    v_cmp_eq_u32 vcc, 0, v9
    s_nop 1
    v_cndmask_b32 v240, 0, v8, vcc
    v_cmp_eq_u32 vcc, 1, v9
    s_nop 1
    v_cndmask_b32 v241, 0, v8, vcc
    v_cmp_eq_u32 vcc, 2, v9
    s_nop 1
    v_cndmask_b32 v242, 0, v8, vcc
    v_cmp_eq_u32 vcc, 3, v9
    s_nop 1
    v_cndmask_b32 v243, 0, v8, vcc
    s_waitcnt lgkmcnt(0)
    s_barrier
L_moe_d:
    s_cmp_lt_u32 s25, 4
    s_cbranch_scc1 L_phase2
    s_cmp_lt_u32 s25, 6
    s_cbranch_scc1 L_wo
    s_mov_b32 s44, s78
    s_and_b32 s45, s79, 0xffff
    s_mov_b32 s46, 0x700000
    s_mov_b32 s47, 0x20000
    s_lshr_b32 s50, s2, 4
    s_lshl_b32 s50, s50, 1
    s_add_u32 s50, s50, s25
    s_sub_u32 s50, s50, 6
    s_mul_i32 s51, s50, 14
    s_and_b32 s27, s2, 15
    v_lshrrev_b32 v1, 3, v0
    v_and_b32 v3, 7, v0
    v_lshlrev_b32 v3, 4, v3
    v_lshlrev_b32 v17, 11, v1
    v_add_u32 v17, v17, v3
    s_lshl_b32 s30, s51, 14
    s_lshl_b32 s31, s27, 7
    s_add_u32 s30, s30, s31
    buffer_load_dwordx4 v[64:67], v17, s[44:47], s30 offen nt
    s_add_u32 s30, s30, 16384
    buffer_load_dwordx4 v[68:71], v17, s[44:47], s30 offen nt
    s_add_u32 s30, s30, 16384
    buffer_load_dwordx4 v[72:75], v17, s[44:47], s30 offen nt
    s_add_u32 s30, s30, 16384
    buffer_load_dwordx4 v[76:79], v17, s[44:47], s30 offen nt
    s_add_u32 s30, s30, 16384
    buffer_load_dwordx4 v[80:83], v17, s[44:47], s30 offen nt
    s_add_u32 s30, s30, 16384
    buffer_load_dwordx4 v[84:87], v17, s[44:47], s30 offen nt
    s_add_u32 s30, s30, 16384
    buffer_load_dwordx4 v[88:91], v17, s[44:47], s30 offen nt
    s_add_u32 s30, s30, 16384
    buffer_load_dwordx4 v[92:95], v17, s[44:47], s30 offen nt
    s_add_u32 s30, s30, 16384
    buffer_load_dwordx4 v[96:99], v17, s[44:47], s30 offen nt
    s_add_u32 s30, s30, 16384
    buffer_load_dwordx4 v[100:103], v17, s[44:47], s30 offen nt
    s_add_u32 s30, s30, 16384
    buffer_load_dwordx4 v[104:107], v17, s[44:47], s30 offen nt
    s_add_u32 s30, s30, 16384
    buffer_load_dwordx4 v[108:111], v17, s[44:47], s30 offen nt
    s_add_u32 s30, s30, 16384
    buffer_load_dwordx4 v[112:115], v17, s[44:47], s30 offen nt
    s_add_u32 s30, s30, 16384
    buffer_load_dwordx4 v[116:119], v17, s[44:47], s30 offen nt
    s_add_u32 s30, s30, 16384
    v_mov_b32 v124, v240
    v_mov_b32 v125, v241
    v_mov_b32 v126, v242
    v_mov_b32 v127, v243
    s_mov_b32 s40, s80
    s_and_b32 s41, s81, 0xffff
    s_mov_b32 s42, 0x400000
    s_mov_b32 s43, 0x20000
    s_lshl_b32 s71, s28, 3
    s_add_u32 s71, s71, s25
    s_lshl_b32 s56, s28, 18
    s_lshl_b32 s69, s25, 10
    s_add_u32 s56, s56, s69
    s_lshl_b32 s71, s71, 4
    v_and_b32 v247, 15, v0
    v_add_u32 v246, s71, v247
    v_lshlrev_b32 v246, 11, v246
    v_bfe_u32 v224, v0, 4, 1
    v_lshlrev_b32 v224, 5, v224
    v_lshrrev_b32 v225, 5, v0
    v_lshlrev_b32 v225, 4, v225
    v_add_u32 v224, v224, v225
    s_lshl_b32 s69, s29, 7
    v_add3_u32 v246, v246, v224, s69
    buffer_load_dwordx4 v[248:251], v246, s[8:11], 0 offen
    buffer_load_dwordx4 v[252:255], v246, s[8:11], 0 offen offset:64
    s_and_b32 s71, s71, 127
    v_add_u32 v247, s71, v247
    v_lshlrev_b32 v224, 3, v247
    v_add_u32 v224, 137344, v224
    v_mov_b32 v225, 137248
    ds_read_b64 v[240:241], v224
    ds_read_b64 v[242:243], v225
    v_lshrrev_b32 v245, 4, v0
    v_lshlrev_b32 v245, 4, v245
    s_waitcnt vmcnt(0) lgkmcnt(0)
    v_readfirstlane_b32 s55, v243
    v_mov_b32 v244, v241
    v_permlane16_swap_b32 v248, v250
    v_permlane16_swap_b32 v249, v251
    v_permlane16_swap_b32 v252, v254
    v_permlane16_swap_b32 v253, v255
    v_lshlrev_b32 v224, 16, v248
    v_and_b32 v225, 0xffff0000, v248
    v_add_f32 v248, v224, v240
    v_add_f32 v243, v225, v240
    v_cvt_pk_bf16_f32 v248, v248, v243
    v_and_b32 v243, 0xffff0000, v248
    v_lshlrev_b32 v248, 16, v248
    v_mul_f32 v248, v248, v244
    v_mul_f32 v243, v243, v244
    v_cvt_pk_bf16_f32 v248, v248, v243
    v_and_b32 v243, 0xffff0000, v248
    v_lshlrev_b32 v248, 16, v248
    v_add_f32 v224, v224, v248
    v_add_f32 v225, v225, v243
    v_lshlrev_b32 v226, 16, v249
    v_and_b32 v227, 0xffff0000, v249
    v_add_f32 v249, v226, v240
    v_add_f32 v243, v227, v240
    v_cvt_pk_bf16_f32 v249, v249, v243
    v_and_b32 v243, 0xffff0000, v249
    v_lshlrev_b32 v249, 16, v249
    v_mul_f32 v249, v249, v244
    v_mul_f32 v243, v243, v244
    v_cvt_pk_bf16_f32 v249, v249, v243
    v_and_b32 v243, 0xffff0000, v249
    v_lshlrev_b32 v249, 16, v249
    v_add_f32 v226, v226, v249
    v_add_f32 v227, v227, v243
    v_lshlrev_b32 v228, 16, v250
    v_and_b32 v229, 0xffff0000, v250
    v_add_f32 v250, v228, v240
    v_add_f32 v243, v229, v240
    v_cvt_pk_bf16_f32 v250, v250, v243
    v_and_b32 v243, 0xffff0000, v250
    v_lshlrev_b32 v250, 16, v250
    v_mul_f32 v250, v250, v244
    v_mul_f32 v243, v243, v244
    v_cvt_pk_bf16_f32 v250, v250, v243
    v_and_b32 v243, 0xffff0000, v250
    v_lshlrev_b32 v250, 16, v250
    v_add_f32 v228, v228, v250
    v_add_f32 v229, v229, v243
    v_lshlrev_b32 v230, 16, v251
    v_and_b32 v231, 0xffff0000, v251
    v_add_f32 v251, v230, v240
    v_add_f32 v243, v231, v240
    v_cvt_pk_bf16_f32 v251, v251, v243
    v_and_b32 v243, 0xffff0000, v251
    v_lshlrev_b32 v251, 16, v251
    v_mul_f32 v251, v251, v244
    v_mul_f32 v243, v243, v244
    v_cvt_pk_bf16_f32 v251, v251, v243
    v_and_b32 v243, 0xffff0000, v251
    v_lshlrev_b32 v251, 16, v251
    v_add_f32 v230, v230, v251
    v_add_f32 v231, v231, v243
    v_lshlrev_b32 v232, 16, v252
    v_and_b32 v233, 0xffff0000, v252
    v_add_f32 v252, v232, v240
    v_add_f32 v243, v233, v240
    v_cvt_pk_bf16_f32 v252, v252, v243
    v_and_b32 v243, 0xffff0000, v252
    v_lshlrev_b32 v252, 16, v252
    v_mul_f32 v252, v252, v244
    v_mul_f32 v243, v243, v244
    v_cvt_pk_bf16_f32 v252, v252, v243
    v_and_b32 v243, 0xffff0000, v252
    v_lshlrev_b32 v252, 16, v252
    v_add_f32 v232, v232, v252
    v_add_f32 v233, v233, v243
    v_lshlrev_b32 v234, 16, v253
    v_and_b32 v235, 0xffff0000, v253
    v_add_f32 v253, v234, v240
    v_add_f32 v243, v235, v240
    v_cvt_pk_bf16_f32 v253, v253, v243
    v_and_b32 v243, 0xffff0000, v253
    v_lshlrev_b32 v253, 16, v253
    v_mul_f32 v253, v253, v244
    v_mul_f32 v243, v243, v244
    v_cvt_pk_bf16_f32 v253, v253, v243
    v_and_b32 v243, 0xffff0000, v253
    v_lshlrev_b32 v253, 16, v253
    v_add_f32 v234, v234, v253
    v_add_f32 v235, v235, v243
    v_lshlrev_b32 v236, 16, v254
    v_and_b32 v237, 0xffff0000, v254
    v_add_f32 v254, v236, v240
    v_add_f32 v243, v237, v240
    v_cvt_pk_bf16_f32 v254, v254, v243
    v_and_b32 v243, 0xffff0000, v254
    v_lshlrev_b32 v254, 16, v254
    v_mul_f32 v254, v254, v244
    v_mul_f32 v243, v243, v244
    v_cvt_pk_bf16_f32 v254, v254, v243
    v_and_b32 v243, 0xffff0000, v254
    v_lshlrev_b32 v254, 16, v254
    v_add_f32 v236, v236, v254
    v_add_f32 v237, v237, v243
    v_lshlrev_b32 v238, 16, v255
    v_and_b32 v239, 0xffff0000, v255
    v_add_f32 v255, v238, v240
    v_add_f32 v243, v239, v240
    v_cvt_pk_bf16_f32 v255, v255, v243
    v_and_b32 v243, 0xffff0000, v255
    v_lshlrev_b32 v255, 16, v255
    v_mul_f32 v255, v255, v244
    v_mul_f32 v243, v243, v244
    v_cvt_pk_bf16_f32 v255, v255, v243
    v_and_b32 v243, 0xffff0000, v255
    v_lshlrev_b32 v255, 16, v255
    v_add_f32 v238, v238, v255
    v_add_f32 v239, v239, v243
    v_and_b32 v248, 60, v0
    v_lshlrev_b32 v248, 5, v248
    v_bfe_u32 v249, v0, 3, 2
    v_lshlrev_b32 v249, 5, v249
    v_add_u32 v248, v248, v249
    v_and_b32 v249, 3, v0
    v_lshlrev_b32 v249, 3, v249
    v_add_u32 v248, v248, v249
    v_xor_b32 v249, 32, v248
    v_xor_b32 v250, 64, v248
    v_xor_b32 v251, 96, v248
    v_add_u32 v252, 0x10000, v248
    v_add_u32 v253, 0x10000, v249
    v_add_u32 v254, 0x10000, v250
    v_add_u32 v255, 0x10000, v251
L_down:
    s_lshr_b32 s33, s51, 3
    s_add_u32 s34, s51, 13
    s_lshr_b32 s34, s34, 3
    s_sub_u32 s34, s34, s33
    v_cmp_ge_u32 s[36:37], s34, v0
    v_and_b32 v12, 7, v0
    v_lshlrev_b32 v13, 7, v0
    s_lshl_b32 s33, s33, 7
    s_add_u32 s33, s33, 0x5b3000
    s_mov_b64 exec, s[36:37]
    s_mov_b32 s39, 131072
LP_45:
    v_mov_b32 v14, 0
    buffer_atomic_add v14, v13, s[16:19], s33 offen sc0 sc1
    s_waitcnt vmcnt(0)
    v_cmp_gt_u32 vcc, 6, v14
    s_cbranch_vccz LD_46
    s_sleep 8
    s_sub_u32 s39, s39, 1
    s_cbranch_scc0 LP_45
LD_46:
    s_mov_b64 exec, -1
    v_add_u32 v14, 0, v1
    v_add_u32 v14, s51, v14
    v_min_u32 v14, 447, v14
    v_lshrrev_b32 v15, 2, v14
    v_lshlrev_b32 v15, 7, v15
    v_and_b32 v14, 3, v14
    v_lshlrev_b32 v14, 2, v14
    v_add3_u32 v14, v14, v15, v3
    s_mov_b32 s33, 0x560000
    buffer_load_dword v20, v14, s[16:19], s33 offen sc1
    s_add_u32 s33, s33, 14336
    buffer_load_dword v21, v14, s[16:19], s33 offen sc1
    s_add_u32 s33, s33, 14336
    buffer_load_dword v22, v14, s[16:19], s33 offen sc1
    s_add_u32 s33, s33, 14336
    buffer_load_dword v23, v14, s[16:19], s33 offen sc1
    s_add_u32 s33, s33, 14336
    buffer_load_dword v24, v14, s[16:19], s33 offen sc1
    s_add_u32 s33, s33, 14336
    buffer_load_dword v25, v14, s[16:19], s33 offen sc1
    s_add_u32 s33, s33, 14336
    v_add_u32 v14, 8, v1
    v_add_u32 v14, s51, v14
    v_min_u32 v14, 447, v14
    v_lshrrev_b32 v15, 2, v14
    v_lshlrev_b32 v15, 7, v15
    v_and_b32 v14, 3, v14
    v_lshlrev_b32 v14, 2, v14
    v_add3_u32 v14, v14, v15, v3
    s_mov_b32 s33, 0x560000
    buffer_load_dword v26, v14, s[16:19], s33 offen sc1
    s_add_u32 s33, s33, 14336
    buffer_load_dword v27, v14, s[16:19], s33 offen sc1
    s_add_u32 s33, s33, 14336
    buffer_load_dword v28, v14, s[16:19], s33 offen sc1
    s_add_u32 s33, s33, 14336
    buffer_load_dword v29, v14, s[16:19], s33 offen sc1
    s_add_u32 s33, s33, 14336
    buffer_load_dword v30, v14, s[16:19], s33 offen sc1
    s_add_u32 s33, s33, 14336
    buffer_load_dword v31, v14, s[16:19], s33 offen sc1
    s_add_u32 s33, s33, 14336
    v_lshlrev_b32 v17, 2, v1
    s_waitcnt vmcnt(0)
    v_add_f32 v20, v20, v22
    v_add_f32 v21, v21, v23
    v_add_f32 v20, v20, v24
    v_add_f32 v21, v21, v25
    v_cvt_pk_bf16_f32 v20, v20, v20
    v_and_b32 v20, 0xffff0000, v20
    v_cvt_pk_bf16_f32 v21, v21, v21
    v_and_b32 v21, 0xffff0000, v21
    v_mov_b32 v22, v20
    v_mul_f32 v22, 0xbfb8aa3b, v22
    v_exp_f32 v22, v22
    s_nop 0
    v_add_f32 v22, 1.0, v22
    v_rcp_f32 v22, v22
    s_nop 0
    v_mul_f32 v20, v20, v22
    v_cvt_pk_bf16_f32 v20, v20, v20
    v_and_b32 v20, 0xffff0000, v20
    v_mul_f32 v20, v20, v21
    v_cvt_pk_bf16_f32 v14, v20, v20
    v_add_f32 v26, v26, v28
    v_add_f32 v27, v27, v29
    v_add_f32 v26, v26, v30
    v_add_f32 v27, v27, v31
    v_cvt_pk_bf16_f32 v26, v26, v26
    v_and_b32 v26, 0xffff0000, v26
    v_cvt_pk_bf16_f32 v27, v27, v27
    v_and_b32 v27, 0xffff0000, v27
    v_mov_b32 v28, v26
    v_mul_f32 v28, 0xbfb8aa3b, v28
    v_exp_f32 v28, v28
    s_nop 0
    v_add_f32 v28, 1.0, v28
    v_rcp_f32 v28, v28
    s_nop 0
    v_mul_f32 v26, v26, v28
    v_cvt_pk_bf16_f32 v26, v26, v26
    v_and_b32 v26, 0xffff0000, v26
    v_mul_f32 v26, v26, v27
    v_cvt_pk_bf16_f32 v15, v26, v26
    ds_bpermute_b32 v20, v17, v14 offset:0
    ds_bpermute_b32 v21, v17, v14 offset:32
    ds_bpermute_b32 v22, v17, v14 offset:64
    ds_bpermute_b32 v23, v17, v14 offset:96
    ds_bpermute_b32 v24, v17, v14 offset:128
    ds_bpermute_b32 v25, v17, v14 offset:160
    ds_bpermute_b32 v26, v17, v14 offset:192
    ds_bpermute_b32 v27, v17, v14 offset:224
    ds_bpermute_b32 v28, v17, v15 offset:0
    ds_bpermute_b32 v29, v17, v15 offset:32
    ds_bpermute_b32 v30, v17, v15 offset:64
    ds_bpermute_b32 v31, v17, v15 offset:96
    ds_bpermute_b32 v32, v17, v15 offset:128
    ds_bpermute_b32 v33, v17, v15 offset:160
    s_waitcnt lgkmcnt(0)
    v_and_b32 v12, v20, v124
    v_and_b32 v13, v20, v125
    v_and_b32 v14, v20, v126
    v_and_b32 v15, v20, v127
    s_waitcnt vmcnt(13)
    s_nop 0
    v_mfma_f32_16x16x32_bf16 v[8:11], v[64:67], v[12:15], 0
    v_and_b32 v16, v21, v124
    v_and_b32 v17, v21, v125
    v_and_b32 v18, v21, v126
    v_and_b32 v19, v21, v127
    s_waitcnt vmcnt(12)
    s_nop 0
    v_mfma_f32_16x16x32_bf16 v[8:11], v[68:71], v[16:19], v[8:11]
    v_and_b32 v12, v22, v124
    v_and_b32 v13, v22, v125
    v_and_b32 v14, v22, v126
    v_and_b32 v15, v22, v127
    s_waitcnt vmcnt(11)
    s_nop 0
    v_mfma_f32_16x16x32_bf16 v[8:11], v[72:75], v[12:15], v[8:11]
    v_and_b32 v16, v23, v124
    v_and_b32 v17, v23, v125
    v_and_b32 v18, v23, v126
    v_and_b32 v19, v23, v127
    s_waitcnt vmcnt(10)
    s_nop 0
    v_mfma_f32_16x16x32_bf16 v[8:11], v[76:79], v[16:19], v[8:11]
    v_and_b32 v12, v24, v124
    v_and_b32 v13, v24, v125
    v_and_b32 v14, v24, v126
    v_and_b32 v15, v24, v127
    s_waitcnt vmcnt(9)
    s_nop 0
    v_mfma_f32_16x16x32_bf16 v[8:11], v[80:83], v[12:15], v[8:11]
    v_and_b32 v16, v25, v124
    v_and_b32 v17, v25, v125
    v_and_b32 v18, v25, v126
    v_and_b32 v19, v25, v127
    s_waitcnt vmcnt(8)
    s_nop 0
    v_mfma_f32_16x16x32_bf16 v[8:11], v[84:87], v[16:19], v[8:11]
    v_and_b32 v12, v26, v124
    v_and_b32 v13, v26, v125
    v_and_b32 v14, v26, v126
    v_and_b32 v15, v26, v127
    s_waitcnt vmcnt(7)
    s_nop 0
    v_mfma_f32_16x16x32_bf16 v[8:11], v[88:91], v[12:15], v[8:11]
    v_and_b32 v16, v27, v124
    v_and_b32 v17, v27, v125
    v_and_b32 v18, v27, v126
    v_and_b32 v19, v27, v127
    s_waitcnt vmcnt(6)
    s_nop 0
    v_mfma_f32_16x16x32_bf16 v[8:11], v[92:95], v[16:19], v[8:11]
    v_and_b32 v12, v28, v124
    v_and_b32 v13, v28, v125
    v_and_b32 v14, v28, v126
    v_and_b32 v15, v28, v127
    s_waitcnt vmcnt(5)
    s_nop 0
    v_mfma_f32_16x16x32_bf16 v[8:11], v[96:99], v[12:15], v[8:11]
    v_and_b32 v16, v29, v124
    v_and_b32 v17, v29, v125
    v_and_b32 v18, v29, v126
    v_and_b32 v19, v29, v127
    s_waitcnt vmcnt(4)
    s_nop 0
    v_mfma_f32_16x16x32_bf16 v[8:11], v[100:103], v[16:19], v[8:11]
    v_and_b32 v12, v30, v124
    v_and_b32 v13, v30, v125
    v_and_b32 v14, v30, v126
    v_and_b32 v15, v30, v127
    s_waitcnt vmcnt(3)
    s_nop 0
    v_mfma_f32_16x16x32_bf16 v[8:11], v[104:107], v[12:15], v[8:11]
    v_and_b32 v16, v31, v124
    v_and_b32 v17, v31, v125
    v_and_b32 v18, v31, v126
    v_and_b32 v19, v31, v127
    s_waitcnt vmcnt(2)
    s_nop 0
    v_mfma_f32_16x16x32_bf16 v[8:11], v[108:111], v[16:19], v[8:11]
    v_and_b32 v12, v32, v124
    v_and_b32 v13, v32, v125
    v_and_b32 v14, v32, v126
    v_and_b32 v15, v32, v127
    s_waitcnt vmcnt(1)
    s_nop 0
    v_mfma_f32_16x16x32_bf16 v[8:11], v[112:115], v[12:15], v[8:11]
    v_and_b32 v16, v33, v124
    v_and_b32 v17, v33, v125
    v_and_b32 v18, v33, v126
    v_and_b32 v19, v33, v127
    s_waitcnt vmcnt(0)
    s_nop 0
    v_mfma_f32_16x16x32_bf16 v[8:11], v[116:119], v[16:19], v[8:11]
    v_lshrrev_b32 v16, 4, v0
    v_lshlrev_b32 v16, 7, v16
    v_add_u32 v16, v16, v3
    s_nop 5
    v_mov_b32 v12, v8
    v_mov_b32 v13, v9
    v_mov_b32 v14, v10
    v_mov_b32 v15, v11
    v_permlane32_swap_b32 v8, v12
    v_permlane32_swap_b32 v9, v13
    v_permlane32_swap_b32 v10, v14
    v_permlane32_swap_b32 v11, v15
    v_add_f32_dpp v8, v12, v8 row_ror:8 row_mask:0xf bank_mask:0xf
    v_add_f32_dpp v9, v13, v9 row_ror:8 row_mask:0xf bank_mask:0xf
    v_add_f32_dpp v10, v14, v10 row_ror:8 row_mask:0xf bank_mask:0xf
    v_add_f32_dpp v11, v15, v11 row_ror:8 row_mask:0xf bank_mask:0xf
    s_lshl_b32 s30, s50, 12
    s_lshl_b32 s31, s27, 8
    s_add_u32 s30, s30, s31
    s_add_u32 s30, s30, 0x580000
    s_mov_b32 exec_lo, 0x00ff00ff
    s_mov_b32 exec_hi, 0
    buffer_store_dwordx4 v[8:11], v16, s[16:19], s30 offen sc1
    s_mov_b64 exec, -1
    s_lshl_b32 s30, s27, 7
    s_add_u32 s30, s30, 0x5b5000
    v_mov_b32 v5, 1
    s_mov_b64 exec, 1
    s_waitcnt vmcnt(0)
    buffer_atomic_add v5, v2, s[16:19], s30 offen sc1
    s_mov_b64 exec, -1
    s_setprio 1
    s_branch L_y1b
L_phase2:
    s_mov_b32 s40, s80
    s_and_b32 s41, s81, 0xffff
    s_mov_b32 s42, 0x400000
    s_mov_b32 s43, 0x20000
    s_lshl_b32 s71, s28, 3
    s_add_u32 s71, s71, s25
    s_lshl_b32 s56, s28, 18
    s_lshl_b32 s69, s25, 10
    s_add_u32 s56, s56, s69
    s_lshl_b32 s71, s71, 4
    v_and_b32 v247, 15, v0
    v_add_u32 v246, s71, v247
    v_lshlrev_b32 v246, 11, v246
    v_bfe_u32 v224, v0, 4, 1
    v_lshlrev_b32 v224, 5, v224
    v_lshrrev_b32 v225, 5, v0
    v_lshlrev_b32 v225, 4, v225
    v_add_u32 v224, v224, v225
    s_lshl_b32 s69, s29, 7
    v_add3_u32 v246, v246, v224, s69
    buffer_load_dwordx4 v[248:251], v246, s[8:11], 0 offen
    buffer_load_dwordx4 v[252:255], v246, s[8:11], 0 offen offset:64
    s_and_b32 s71, s71, 127
    v_add_u32 v247, s71, v247
    v_lshlrev_b32 v224, 3, v247
    v_add_u32 v224, 137344, v224
    v_mov_b32 v225, 137248
    ds_read_b64 v[240:241], v224
    ds_read_b64 v[242:243], v225
    v_lshrrev_b32 v245, 4, v0
    v_lshlrev_b32 v245, 4, v245
    s_waitcnt vmcnt(0) lgkmcnt(0)
    v_readfirstlane_b32 s55, v243
    v_mov_b32 v244, v241
    v_permlane16_swap_b32 v248, v250
    v_permlane16_swap_b32 v249, v251
    v_permlane16_swap_b32 v252, v254
    v_permlane16_swap_b32 v253, v255
    v_lshlrev_b32 v224, 16, v248
    v_and_b32 v225, 0xffff0000, v248
    v_add_f32 v248, v224, v240
    v_add_f32 v243, v225, v240
    v_cvt_pk_bf16_f32 v248, v248, v243
    v_and_b32 v243, 0xffff0000, v248
    v_lshlrev_b32 v248, 16, v248
    v_mul_f32 v248, v248, v244
    v_mul_f32 v243, v243, v244
    v_cvt_pk_bf16_f32 v248, v248, v243
    v_and_b32 v243, 0xffff0000, v248
    v_lshlrev_b32 v248, 16, v248
    v_add_f32 v224, v224, v248
    v_add_f32 v225, v225, v243
    v_lshlrev_b32 v226, 16, v249
    v_and_b32 v227, 0xffff0000, v249
    v_add_f32 v249, v226, v240
    v_add_f32 v243, v227, v240
    v_cvt_pk_bf16_f32 v249, v249, v243
    v_and_b32 v243, 0xffff0000, v249
    v_lshlrev_b32 v249, 16, v249
    v_mul_f32 v249, v249, v244
    v_mul_f32 v243, v243, v244
    v_cvt_pk_bf16_f32 v249, v249, v243
    v_and_b32 v243, 0xffff0000, v249
    v_lshlrev_b32 v249, 16, v249
    v_add_f32 v226, v226, v249
    v_add_f32 v227, v227, v243
    v_lshlrev_b32 v228, 16, v250
    v_and_b32 v229, 0xffff0000, v250
    v_add_f32 v250, v228, v240
    v_add_f32 v243, v229, v240
    v_cvt_pk_bf16_f32 v250, v250, v243
    v_and_b32 v243, 0xffff0000, v250
    v_lshlrev_b32 v250, 16, v250
    v_mul_f32 v250, v250, v244
    v_mul_f32 v243, v243, v244
    v_cvt_pk_bf16_f32 v250, v250, v243
    v_and_b32 v243, 0xffff0000, v250
    v_lshlrev_b32 v250, 16, v250
    v_add_f32 v228, v228, v250
    v_add_f32 v229, v229, v243
    v_lshlrev_b32 v230, 16, v251
    v_and_b32 v231, 0xffff0000, v251
    v_add_f32 v251, v230, v240
    v_add_f32 v243, v231, v240
    v_cvt_pk_bf16_f32 v251, v251, v243
    v_and_b32 v243, 0xffff0000, v251
    v_lshlrev_b32 v251, 16, v251
    v_mul_f32 v251, v251, v244
    v_mul_f32 v243, v243, v244
    v_cvt_pk_bf16_f32 v251, v251, v243
    v_and_b32 v243, 0xffff0000, v251
    v_lshlrev_b32 v251, 16, v251
    v_add_f32 v230, v230, v251
    v_add_f32 v231, v231, v243
    v_lshlrev_b32 v232, 16, v252
    v_and_b32 v233, 0xffff0000, v252
    v_add_f32 v252, v232, v240
    v_add_f32 v243, v233, v240
    v_cvt_pk_bf16_f32 v252, v252, v243
    v_and_b32 v243, 0xffff0000, v252
    v_lshlrev_b32 v252, 16, v252
    v_mul_f32 v252, v252, v244
    v_mul_f32 v243, v243, v244
    v_cvt_pk_bf16_f32 v252, v252, v243
    v_and_b32 v243, 0xffff0000, v252
    v_lshlrev_b32 v252, 16, v252
    v_add_f32 v232, v232, v252
    v_add_f32 v233, v233, v243
    v_lshlrev_b32 v234, 16, v253
    v_and_b32 v235, 0xffff0000, v253
    v_add_f32 v253, v234, v240
    v_add_f32 v243, v235, v240
    v_cvt_pk_bf16_f32 v253, v253, v243
    v_and_b32 v243, 0xffff0000, v253
    v_lshlrev_b32 v253, 16, v253
    v_mul_f32 v253, v253, v244
    v_mul_f32 v243, v243, v244
    v_cvt_pk_bf16_f32 v253, v253, v243
    v_and_b32 v243, 0xffff0000, v253
    v_lshlrev_b32 v253, 16, v253
    v_add_f32 v234, v234, v253
    v_add_f32 v235, v235, v243
    v_lshlrev_b32 v236, 16, v254
    v_and_b32 v237, 0xffff0000, v254
    v_add_f32 v254, v236, v240
    v_add_f32 v243, v237, v240
    v_cvt_pk_bf16_f32 v254, v254, v243
    v_and_b32 v243, 0xffff0000, v254
    v_lshlrev_b32 v254, 16, v254
    v_mul_f32 v254, v254, v244
    v_mul_f32 v243, v243, v244
    v_cvt_pk_bf16_f32 v254, v254, v243
    v_and_b32 v243, 0xffff0000, v254
    v_lshlrev_b32 v254, 16, v254
    v_add_f32 v236, v236, v254
    v_add_f32 v237, v237, v243
    v_lshlrev_b32 v238, 16, v255
    v_and_b32 v239, 0xffff0000, v255
    v_add_f32 v255, v238, v240
    v_add_f32 v243, v239, v240
    v_cvt_pk_bf16_f32 v255, v255, v243
    v_and_b32 v243, 0xffff0000, v255
    v_lshlrev_b32 v255, 16, v255
    v_mul_f32 v255, v255, v244
    v_mul_f32 v243, v243, v244
    v_cvt_pk_bf16_f32 v255, v255, v243
    v_and_b32 v243, 0xffff0000, v255
    v_lshlrev_b32 v255, 16, v255
    v_add_f32 v238, v238, v255
    v_add_f32 v239, v239, v243
    v_and_b32 v248, 60, v0
    v_lshlrev_b32 v248, 5, v248
    v_bfe_u32 v249, v0, 3, 2
    v_lshlrev_b32 v249, 5, v249
    v_add_u32 v248, v248, v249
    v_and_b32 v249, 3, v0
    v_lshlrev_b32 v249, 3, v249
    v_add_u32 v248, v248, v249
    v_xor_b32 v249, 32, v248
    v_xor_b32 v250, 64, v248
    v_xor_b32 v251, 96, v248
    v_add_u32 v252, 0x10000, v248
    v_add_u32 v253, 0x10000, v249
    v_add_u32 v254, 0x10000, v250
    v_add_u32 v255, 0x10000, v251
L_phase2b:
    s_cmp_lt_u32 s25, 4
    s_cbranch_scc1 L_y1b
    s_setprio 1
    s_cmp_lg_u32 s25, 4
    s_cbranch_scc1 L_y1b
    s_cmp_eq_u32 s57, 1
    s_cbranch_scc1 L_y0
    v_mov_b32 v8, 137280
    s_mov_b32 s39, 1048576
LW_47:
    ds_read_b32 v9, v8 offset:40
    s_waitcnt lgkmcnt(0)
    v_cmp_eq_u32 vcc, 0, v9
    s_cbranch_vccz LE_48
    s_sleep 2
    s_sub_u32 s39, s39, 1
    s_cbranch_scc0 LW_47
LE_48:
L_y0:
    s_setprio 0
    v_lshlrev_b32 v8, 7, v0
    s_mul_i32 s30, s28, 1640
    s_lshr_b32 s31, s30, 10
    s_add_u32 s30, s30, 1435
    s_lshr_b32 s30, s30, 10
    s_sub_u32 s30, s30, s31
    s_add_u32 s30, s30, 1
    s_lshl_b32 s30, s30, 3
    s_lshl_b32 s31, s28, 9
    s_add_u32 s31, s31, 0x5b1000
    s_mov_b64 exec, 15
    s_mov_b32 s39, 131072
LP_49:
    v_mov_b32 v9, 0
    buffer_atomic_add v9, v8, s[16:19], s31 offen sc0 sc1
    s_waitcnt vmcnt(0)
    v_cmp_gt_u32 vcc, s30, v9
    s_cbranch_vccz LD_50
    s_sleep 1
    s_sub_u32 s39, s39, 1
    s_cbranch_scc0 LP_49
LD_50:
    s_mov_b64 exec, -1
    s_setprio 1
L_y1b:
    s_barrier
    s_lshr_b32 s30, s55, 7
    s_bfe_u32 s57, s55, 0x30004
    s_cmp_eq_u32 s30, s28
    s_cselect_b32 s57, s57, 8
    buffer_load_dwordx4 v[64:67], v2, s[16:19], s56 offen sc1
    s_add_u32 s56, s56, 8192
    buffer_load_dwordx4 v[68:71], v2, s[16:19], s56 offen sc1
    s_add_u32 s56, s56, 8192
    buffer_load_dwordx4 v[72:75], v2, s[16:19], s56 offen sc1
    s_add_u32 s56, s56, 8192
    buffer_load_dwordx4 v[76:79], v2, s[16:19], s56 offen sc1
    s_add_u32 s56, s56, 8192
    buffer_load_dwordx4 v[80:83], v2, s[16:19], s56 offen sc1
    s_add_u32 s56, s56, 8192
    buffer_load_dwordx4 v[84:87], v2, s[16:19], s56 offen sc1
    s_add_u32 s56, s56, 8192
    buffer_load_dwordx4 v[88:91], v2, s[16:19], s56 offen sc1
    s_add_u32 s56, s56, 8192
    buffer_load_dwordx4 v[92:95], v2, s[16:19], s56 offen sc1
    s_add_u32 s56, s56, 8192
    ds_read_b64_tr_b16 v[16:17], v248 offset:0
    ds_read_b64_tr_b16 v[18:19], v248 offset:2048
    ds_read_b64_tr_b16 v[20:21], v249 offset:0
    ds_read_b64_tr_b16 v[22:23], v249 offset:2048
    ds_read_b64_tr_b16 v[24:25], v250 offset:0
    ds_read_b64_tr_b16 v[26:27], v250 offset:2048
    ds_read_b64_tr_b16 v[28:29], v251 offset:0
    ds_read_b64_tr_b16 v[30:31], v251 offset:2048
    ds_read_b64_tr_b16 v[32:33], v248 offset:4096
    ds_read_b64_tr_b16 v[34:35], v248 offset:6144
    ds_read_b64_tr_b16 v[36:37], v249 offset:4096
    ds_read_b64_tr_b16 v[38:39], v249 offset:6144
    ds_read_b64_tr_b16 v[40:41], v250 offset:4096
    ds_read_b64_tr_b16 v[42:43], v250 offset:6144
    ds_read_b64_tr_b16 v[44:45], v251 offset:4096
    ds_read_b64_tr_b16 v[46:47], v251 offset:6144
    buffer_load_dwordx4 v[96:99], v2, s[16:19], s56 offen sc1
    s_add_u32 s56, s56, 8192
    s_waitcnt vmcnt(8) lgkmcnt(8)
    v_mfma_f32_16x16x32_bf16 v[224:227], v[16:19], v[64:67], v[224:227]
    ds_read_b64_tr_b16 v[48:49], v248 offset:8192
    ds_read_b64_tr_b16 v[50:51], v248 offset:10240
    v_mfma_f32_16x16x32_bf16 v[228:231], v[20:23], v[64:67], v[228:231]
    ds_read_b64_tr_b16 v[52:53], v249 offset:8192
    ds_read_b64_tr_b16 v[54:55], v249 offset:10240
    v_mfma_f32_16x16x32_bf16 v[232:235], v[24:27], v[64:67], v[232:235]
    ds_read_b64_tr_b16 v[56:57], v250 offset:8192
    ds_read_b64_tr_b16 v[58:59], v250 offset:10240
    v_mfma_f32_16x16x32_bf16 v[236:239], v[28:31], v[64:67], v[236:239]
    ds_read_b64_tr_b16 v[60:61], v251 offset:8192
    ds_read_b64_tr_b16 v[62:63], v251 offset:10240
    buffer_load_dwordx4 v[100:103], v2, s[16:19], s56 offen sc1
    s_add_u32 s56, s56, 8192
    s_waitcnt vmcnt(8) lgkmcnt(8)
    v_mfma_f32_16x16x32_bf16 v[224:227], v[32:35], v[68:71], v[224:227]
    ds_read_b64_tr_b16 v[16:17], v248 offset:12288
    ds_read_b64_tr_b16 v[18:19], v248 offset:14336
    v_mfma_f32_16x16x32_bf16 v[228:231], v[36:39], v[68:71], v[228:231]
    ds_read_b64_tr_b16 v[20:21], v249 offset:12288
    ds_read_b64_tr_b16 v[22:23], v249 offset:14336
    v_mfma_f32_16x16x32_bf16 v[232:235], v[40:43], v[68:71], v[232:235]
    ds_read_b64_tr_b16 v[24:25], v250 offset:12288
    ds_read_b64_tr_b16 v[26:27], v250 offset:14336
    v_mfma_f32_16x16x32_bf16 v[236:239], v[44:47], v[68:71], v[236:239]
    ds_read_b64_tr_b16 v[28:29], v251 offset:12288
    ds_read_b64_tr_b16 v[30:31], v251 offset:14336
    buffer_load_dwordx4 v[104:107], v2, s[16:19], s56 offen sc1
    s_add_u32 s56, s56, 8192
    s_waitcnt vmcnt(8) lgkmcnt(8)
    v_mfma_f32_16x16x32_bf16 v[224:227], v[48:51], v[72:75], v[224:227]
    ds_read_b64_tr_b16 v[32:33], v248 offset:16384
    ds_read_b64_tr_b16 v[34:35], v248 offset:18432
    v_mfma_f32_16x16x32_bf16 v[228:231], v[52:55], v[72:75], v[228:231]
    ds_read_b64_tr_b16 v[36:37], v249 offset:16384
    ds_read_b64_tr_b16 v[38:39], v249 offset:18432
    v_mfma_f32_16x16x32_bf16 v[232:235], v[56:59], v[72:75], v[232:235]
    ds_read_b64_tr_b16 v[40:41], v250 offset:16384
    ds_read_b64_tr_b16 v[42:43], v250 offset:18432
    v_mfma_f32_16x16x32_bf16 v[236:239], v[60:63], v[72:75], v[236:239]
    ds_read_b64_tr_b16 v[44:45], v251 offset:16384
    ds_read_b64_tr_b16 v[46:47], v251 offset:18432
    buffer_load_dwordx4 v[108:111], v2, s[16:19], s56 offen sc1
    s_add_u32 s56, s56, 8192
    s_waitcnt vmcnt(8) lgkmcnt(8)
    v_mfma_f32_16x16x32_bf16 v[224:227], v[16:19], v[76:79], v[224:227]
    ds_read_b64_tr_b16 v[48:49], v248 offset:20480
    ds_read_b64_tr_b16 v[50:51], v248 offset:22528
    v_mfma_f32_16x16x32_bf16 v[228:231], v[20:23], v[76:79], v[228:231]
    ds_read_b64_tr_b16 v[52:53], v249 offset:20480
    ds_read_b64_tr_b16 v[54:55], v249 offset:22528
    v_mfma_f32_16x16x32_bf16 v[232:235], v[24:27], v[76:79], v[232:235]
    ds_read_b64_tr_b16 v[56:57], v250 offset:20480
    ds_read_b64_tr_b16 v[58:59], v250 offset:22528
    v_mfma_f32_16x16x32_bf16 v[236:239], v[28:31], v[76:79], v[236:239]
    ds_read_b64_tr_b16 v[60:61], v251 offset:20480
    ds_read_b64_tr_b16 v[62:63], v251 offset:22528
    buffer_load_dwordx4 v[112:115], v2, s[16:19], s56 offen sc1
    s_add_u32 s56, s56, 8192
    s_waitcnt vmcnt(8) lgkmcnt(8)
    v_mfma_f32_16x16x32_bf16 v[224:227], v[32:35], v[80:83], v[224:227]
    ds_read_b64_tr_b16 v[16:17], v248 offset:24576
    ds_read_b64_tr_b16 v[18:19], v248 offset:26624
    v_mfma_f32_16x16x32_bf16 v[228:231], v[36:39], v[80:83], v[228:231]
    ds_read_b64_tr_b16 v[20:21], v249 offset:24576
    ds_read_b64_tr_b16 v[22:23], v249 offset:26624
    v_mfma_f32_16x16x32_bf16 v[232:235], v[40:43], v[80:83], v[232:235]
    ds_read_b64_tr_b16 v[24:25], v250 offset:24576
    ds_read_b64_tr_b16 v[26:27], v250 offset:26624
    v_mfma_f32_16x16x32_bf16 v[236:239], v[44:47], v[80:83], v[236:239]
    ds_read_b64_tr_b16 v[28:29], v251 offset:24576
    ds_read_b64_tr_b16 v[30:31], v251 offset:26624
    buffer_load_dwordx4 v[116:119], v2, s[16:19], s56 offen sc1
    s_add_u32 s56, s56, 8192
    s_waitcnt vmcnt(8) lgkmcnt(8)
    v_mfma_f32_16x16x32_bf16 v[224:227], v[48:51], v[84:87], v[224:227]
    ds_read_b64_tr_b16 v[32:33], v248 offset:28672
    ds_read_b64_tr_b16 v[34:35], v248 offset:30720
    v_mfma_f32_16x16x32_bf16 v[228:231], v[52:55], v[84:87], v[228:231]
    ds_read_b64_tr_b16 v[36:37], v249 offset:28672
    ds_read_b64_tr_b16 v[38:39], v249 offset:30720
    v_mfma_f32_16x16x32_bf16 v[232:235], v[56:59], v[84:87], v[232:235]
    ds_read_b64_tr_b16 v[40:41], v250 offset:28672
    ds_read_b64_tr_b16 v[42:43], v250 offset:30720
    v_mfma_f32_16x16x32_bf16 v[236:239], v[60:63], v[84:87], v[236:239]
    ds_read_b64_tr_b16 v[44:45], v251 offset:28672
    ds_read_b64_tr_b16 v[46:47], v251 offset:30720
    buffer_load_dwordx4 v[120:123], v2, s[16:19], s56 offen sc1
    s_add_u32 s56, s56, 8192
    s_waitcnt vmcnt(8) lgkmcnt(8)
    v_mfma_f32_16x16x32_bf16 v[224:227], v[16:19], v[88:91], v[224:227]
    ds_read_b64_tr_b16 v[48:49], v248 offset:32768
    ds_read_b64_tr_b16 v[50:51], v248 offset:34816
    v_mfma_f32_16x16x32_bf16 v[228:231], v[20:23], v[88:91], v[228:231]
    ds_read_b64_tr_b16 v[52:53], v249 offset:32768
    ds_read_b64_tr_b16 v[54:55], v249 offset:34816
    v_mfma_f32_16x16x32_bf16 v[232:235], v[24:27], v[88:91], v[232:235]
    ds_read_b64_tr_b16 v[56:57], v250 offset:32768
    ds_read_b64_tr_b16 v[58:59], v250 offset:34816
    v_mfma_f32_16x16x32_bf16 v[236:239], v[28:31], v[88:91], v[236:239]
    ds_read_b64_tr_b16 v[60:61], v251 offset:32768
    ds_read_b64_tr_b16 v[62:63], v251 offset:34816
    buffer_load_dwordx4 v[124:127], v2, s[16:19], s56 offen sc1
    s_add_u32 s56, s56, 8192
    s_waitcnt vmcnt(8) lgkmcnt(8)
    v_mfma_f32_16x16x32_bf16 v[224:227], v[32:35], v[92:95], v[224:227]
    ds_read_b64_tr_b16 v[16:17], v248 offset:36864
    ds_read_b64_tr_b16 v[18:19], v248 offset:38912
    v_mfma_f32_16x16x32_bf16 v[228:231], v[36:39], v[92:95], v[228:231]
    ds_read_b64_tr_b16 v[20:21], v249 offset:36864
    ds_read_b64_tr_b16 v[22:23], v249 offset:38912
    v_mfma_f32_16x16x32_bf16 v[232:235], v[40:43], v[92:95], v[232:235]
    ds_read_b64_tr_b16 v[24:25], v250 offset:36864
    ds_read_b64_tr_b16 v[26:27], v250 offset:38912
    v_mfma_f32_16x16x32_bf16 v[236:239], v[44:47], v[92:95], v[236:239]
    ds_read_b64_tr_b16 v[28:29], v251 offset:36864
    ds_read_b64_tr_b16 v[30:31], v251 offset:38912
    buffer_load_dwordx4 v[128:131], v2, s[16:19], s56 offen sc1
    s_add_u32 s56, s56, 8192
    s_waitcnt vmcnt(8) lgkmcnt(8)
    v_mfma_f32_16x16x32_bf16 v[224:227], v[48:51], v[96:99], v[224:227]
    ds_read_b64_tr_b16 v[32:33], v248 offset:40960
    ds_read_b64_tr_b16 v[34:35], v248 offset:43008
    v_mfma_f32_16x16x32_bf16 v[228:231], v[52:55], v[96:99], v[228:231]
    ds_read_b64_tr_b16 v[36:37], v249 offset:40960
    ds_read_b64_tr_b16 v[38:39], v249 offset:43008
    v_mfma_f32_16x16x32_bf16 v[232:235], v[56:59], v[96:99], v[232:235]
    ds_read_b64_tr_b16 v[40:41], v250 offset:40960
    ds_read_b64_tr_b16 v[42:43], v250 offset:43008
    v_mfma_f32_16x16x32_bf16 v[236:239], v[60:63], v[96:99], v[236:239]
    ds_read_b64_tr_b16 v[44:45], v251 offset:40960
    ds_read_b64_tr_b16 v[46:47], v251 offset:43008
    buffer_load_dwordx4 v[132:135], v2, s[16:19], s56 offen sc1
    s_add_u32 s56, s56, 8192
    s_waitcnt vmcnt(8) lgkmcnt(8)
    v_mfma_f32_16x16x32_bf16 v[224:227], v[16:19], v[100:103], v[224:227]
    ds_read_b64_tr_b16 v[48:49], v248 offset:45056
    ds_read_b64_tr_b16 v[50:51], v248 offset:47104
    v_mfma_f32_16x16x32_bf16 v[228:231], v[20:23], v[100:103], v[228:231]
    ds_read_b64_tr_b16 v[52:53], v249 offset:45056
    ds_read_b64_tr_b16 v[54:55], v249 offset:47104
    v_mfma_f32_16x16x32_bf16 v[232:235], v[24:27], v[100:103], v[232:235]
    ds_read_b64_tr_b16 v[56:57], v250 offset:45056
    ds_read_b64_tr_b16 v[58:59], v250 offset:47104
    v_mfma_f32_16x16x32_bf16 v[236:239], v[28:31], v[100:103], v[236:239]
    ds_read_b64_tr_b16 v[60:61], v251 offset:45056
    ds_read_b64_tr_b16 v[62:63], v251 offset:47104
    buffer_load_dwordx4 v[136:139], v2, s[16:19], s56 offen sc1
    s_add_u32 s56, s56, 8192
    s_waitcnt vmcnt(8) lgkmcnt(8)
    v_mfma_f32_16x16x32_bf16 v[224:227], v[32:35], v[104:107], v[224:227]
    ds_read_b64_tr_b16 v[16:17], v248 offset:49152
    ds_read_b64_tr_b16 v[18:19], v248 offset:51200
    v_mfma_f32_16x16x32_bf16 v[228:231], v[36:39], v[104:107], v[228:231]
    ds_read_b64_tr_b16 v[20:21], v249 offset:49152
    ds_read_b64_tr_b16 v[22:23], v249 offset:51200
    v_mfma_f32_16x16x32_bf16 v[232:235], v[40:43], v[104:107], v[232:235]
    ds_read_b64_tr_b16 v[24:25], v250 offset:49152
    ds_read_b64_tr_b16 v[26:27], v250 offset:51200
    v_mfma_f32_16x16x32_bf16 v[236:239], v[44:47], v[104:107], v[236:239]
    ds_read_b64_tr_b16 v[28:29], v251 offset:49152
    ds_read_b64_tr_b16 v[30:31], v251 offset:51200
    buffer_load_dwordx4 v[140:143], v2, s[16:19], s56 offen sc1
    s_add_u32 s56, s56, 8192
    s_waitcnt vmcnt(8) lgkmcnt(8)
    v_mfma_f32_16x16x32_bf16 v[224:227], v[48:51], v[108:111], v[224:227]
    ds_read_b64_tr_b16 v[32:33], v248 offset:53248
    ds_read_b64_tr_b16 v[34:35], v248 offset:55296
    v_mfma_f32_16x16x32_bf16 v[228:231], v[52:55], v[108:111], v[228:231]
    ds_read_b64_tr_b16 v[36:37], v249 offset:53248
    ds_read_b64_tr_b16 v[38:39], v249 offset:55296
    v_mfma_f32_16x16x32_bf16 v[232:235], v[56:59], v[108:111], v[232:235]
    ds_read_b64_tr_b16 v[40:41], v250 offset:53248
    ds_read_b64_tr_b16 v[42:43], v250 offset:55296
    v_mfma_f32_16x16x32_bf16 v[236:239], v[60:63], v[108:111], v[236:239]
    ds_read_b64_tr_b16 v[44:45], v251 offset:53248
    ds_read_b64_tr_b16 v[46:47], v251 offset:55296
    buffer_load_dwordx4 v[144:147], v2, s[16:19], s56 offen sc1
    s_add_u32 s56, s56, 8192
    s_waitcnt vmcnt(8) lgkmcnt(8)
    v_mfma_f32_16x16x32_bf16 v[224:227], v[16:19], v[112:115], v[224:227]
    ds_read_b64_tr_b16 v[48:49], v248 offset:57344
    ds_read_b64_tr_b16 v[50:51], v248 offset:59392
    v_mfma_f32_16x16x32_bf16 v[228:231], v[20:23], v[112:115], v[228:231]
    ds_read_b64_tr_b16 v[52:53], v249 offset:57344
    ds_read_b64_tr_b16 v[54:55], v249 offset:59392
    v_mfma_f32_16x16x32_bf16 v[232:235], v[24:27], v[112:115], v[232:235]
    ds_read_b64_tr_b16 v[56:57], v250 offset:57344
    ds_read_b64_tr_b16 v[58:59], v250 offset:59392
    v_mfma_f32_16x16x32_bf16 v[236:239], v[28:31], v[112:115], v[236:239]
    ds_read_b64_tr_b16 v[60:61], v251 offset:57344
    ds_read_b64_tr_b16 v[62:63], v251 offset:59392
    buffer_load_dwordx4 v[148:151], v2, s[16:19], s56 offen sc1
    s_add_u32 s56, s56, 8192
    s_waitcnt vmcnt(8) lgkmcnt(8)
    v_mfma_f32_16x16x32_bf16 v[224:227], v[32:35], v[116:119], v[224:227]
    ds_read_b64_tr_b16 v[16:17], v248 offset:61440
    ds_read_b64_tr_b16 v[18:19], v248 offset:63488
    v_mfma_f32_16x16x32_bf16 v[228:231], v[36:39], v[116:119], v[228:231]
    ds_read_b64_tr_b16 v[20:21], v249 offset:61440
    ds_read_b64_tr_b16 v[22:23], v249 offset:63488
    v_mfma_f32_16x16x32_bf16 v[232:235], v[40:43], v[116:119], v[232:235]
    ds_read_b64_tr_b16 v[24:25], v250 offset:61440
    ds_read_b64_tr_b16 v[26:27], v250 offset:63488
    v_mfma_f32_16x16x32_bf16 v[236:239], v[44:47], v[116:119], v[236:239]
    ds_read_b64_tr_b16 v[28:29], v251 offset:61440
    ds_read_b64_tr_b16 v[30:31], v251 offset:63488
    buffer_load_dwordx4 v[152:155], v2, s[16:19], s56 offen sc1
    s_add_u32 s56, s56, 8192
    s_waitcnt vmcnt(8) lgkmcnt(8)
    v_mfma_f32_16x16x32_bf16 v[224:227], v[48:51], v[120:123], v[224:227]
    ds_read_b64_tr_b16 v[32:33], v252 offset:0
    ds_read_b64_tr_b16 v[34:35], v252 offset:2048
    v_mfma_f32_16x16x32_bf16 v[228:231], v[52:55], v[120:123], v[228:231]
    ds_read_b64_tr_b16 v[36:37], v253 offset:0
    ds_read_b64_tr_b16 v[38:39], v253 offset:2048
    v_mfma_f32_16x16x32_bf16 v[232:235], v[56:59], v[120:123], v[232:235]
    ds_read_b64_tr_b16 v[40:41], v254 offset:0
    ds_read_b64_tr_b16 v[42:43], v254 offset:2048
    v_mfma_f32_16x16x32_bf16 v[236:239], v[60:63], v[120:123], v[236:239]
    ds_read_b64_tr_b16 v[44:45], v255 offset:0
    ds_read_b64_tr_b16 v[46:47], v255 offset:2048
    buffer_load_dwordx4 v[156:159], v2, s[16:19], s56 offen sc1
    s_add_u32 s56, s56, 8192
    s_waitcnt vmcnt(8) lgkmcnt(8)
    v_mfma_f32_16x16x32_bf16 v[224:227], v[16:19], v[124:127], v[224:227]
    ds_read_b64_tr_b16 v[48:49], v252 offset:4096
    ds_read_b64_tr_b16 v[50:51], v252 offset:6144
    v_mfma_f32_16x16x32_bf16 v[228:231], v[20:23], v[124:127], v[228:231]
    ds_read_b64_tr_b16 v[52:53], v253 offset:4096
    ds_read_b64_tr_b16 v[54:55], v253 offset:6144
    v_mfma_f32_16x16x32_bf16 v[232:235], v[24:27], v[124:127], v[232:235]
    ds_read_b64_tr_b16 v[56:57], v254 offset:4096
    ds_read_b64_tr_b16 v[58:59], v254 offset:6144
    v_mfma_f32_16x16x32_bf16 v[236:239], v[28:31], v[124:127], v[236:239]
    ds_read_b64_tr_b16 v[60:61], v255 offset:4096
    ds_read_b64_tr_b16 v[62:63], v255 offset:6144
    s_cmp_lg_u32 s25, 6
    s_cbranch_scc1 L_51
    s_cmp_eq_u32 s57, 8
    s_cbranch_scc1 L_51
    s_lshl_b32 s30, s29, 7
    s_add_u32 s30, s30, 0x5b5000
    s_mov_b64 exec, 1
    s_mov_b32 s39, 131072
LP_52:
    v_mov_b32 v9, 0
    buffer_atomic_add v9, v2, s[16:19], s30 offen sc0 sc1
    s_waitcnt vmcnt(0)
    v_cmp_gt_u32 vcc, 32, v9
    s_cbranch_vccz LD_53
    s_sleep 2
    s_sub_u32 s39, s39, 1
    s_cbranch_scc0 LP_52
LD_53:
    s_mov_b64 exec, -1
    v_lshrrev_b32 v8, 4, v0
    v_lshlrev_b32 v8, 12, v8
    v_and_b32 v9, 15, v0
    v_lshlrev_b32 v9, 4, v9
    v_add_u32 v8, v8, v9
    s_lshl_b32 s30, s29, 8
    s_add_u32 s30, s30, 0x580000
    buffer_load_dwordx4 v[192:195], v8, s[16:19], s30 offen sc1
    s_add_u32 s30, s30, 16384
    buffer_load_dwordx4 v[196:199], v8, s[16:19], s30 offen sc1
    s_add_u32 s30, s30, 16384
    buffer_load_dwordx4 v[200:203], v8, s[16:19], s30 offen sc1
    s_add_u32 s30, s30, 16384
    buffer_load_dwordx4 v[204:207], v8, s[16:19], s30 offen sc1
    s_add_u32 s30, s30, 16384
    buffer_load_dwordx4 v[208:211], v8, s[16:19], s30 offen sc1
    s_add_u32 s30, s30, 16384
    buffer_load_dwordx4 v[212:215], v8, s[16:19], s30 offen sc1
    s_add_u32 s30, s30, 16384
    buffer_load_dwordx4 v[216:219], v8, s[16:19], s30 offen sc1
    s_add_u32 s30, s30, 16384
    buffer_load_dwordx4 v[220:223], v8, s[16:19], s30 offen sc1
    s_add_u32 s30, s30, 16384
    v_bfe_u32 v9, v0, 3, 1
    v_lshlrev_b32 v9, 7, v9
    v_and_b32 v10, 7, v0
    v_lshlrev_b32 v10, 2, v10
    v_add_u32 v9, v9, v10
    v_add_u32 v9, 138496, v9
    s_waitcnt vmcnt(0)
    v_add_f32 v192, v192, v196
    v_add_f32 v193, v193, v197
    v_add_f32 v194, v194, v198
    v_add_f32 v195, v195, v199
    v_add_f32 v192, v192, v200
    v_add_f32 v193, v193, v201
    v_add_f32 v194, v194, v202
    v_add_f32 v195, v195, v203
    v_add_f32 v192, v192, v204
    v_add_f32 v193, v193, v205
    v_add_f32 v194, v194, v206
    v_add_f32 v195, v195, v207
    v_add_f32 v192, v192, v208
    v_add_f32 v193, v193, v209
    v_add_f32 v194, v194, v210
    v_add_f32 v195, v195, v211
    v_add_f32 v192, v192, v212
    v_add_f32 v193, v193, v213
    v_add_f32 v194, v194, v214
    v_add_f32 v195, v195, v215
    v_add_f32 v192, v192, v216
    v_add_f32 v193, v193, v217
    v_add_f32 v194, v194, v218
    v_add_f32 v195, v195, v219
    v_add_f32 v192, v192, v220
    v_add_f32 v193, v193, v221
    v_add_f32 v194, v194, v222
    v_add_f32 v195, v195, v223
    v_mov_b32 v196, v192
    v_mov_b32 v197, v193
    v_mov_b32 v198, v194
    v_mov_b32 v199, v195
    v_permlane16_swap_b32 v192, v196
    v_permlane16_swap_b32 v193, v197
    v_permlane16_swap_b32 v194, v198
    v_permlane16_swap_b32 v195, v199
    v_add_f32 v192, v192, v196
    v_add_f32 v193, v193, v197
    v_add_f32 v194, v194, v198
    v_add_f32 v195, v195, v199
    v_mov_b32 v196, v192
    v_mov_b32 v197, v193
    v_mov_b32 v198, v194
    v_mov_b32 v199, v195
    v_permlane32_swap_b32 v192, v196
    v_permlane32_swap_b32 v193, v197
    v_permlane32_swap_b32 v194, v198
    v_permlane32_swap_b32 v195, v199
    v_add_f32 v192, v192, v196
    v_add_f32 v193, v193, v197
    v_add_f32 v194, v194, v198
    v_add_f32 v195, v195, v199
    v_cvt_pk_bf16_f32 v192, v192, v192
    v_and_b32 v192, 0xffff0000, v192
    v_mul_f32 v192, v192, v242
    v_cvt_pk_bf16_f32 v192, v192, v192
    v_and_b32 v192, 0xffff0000, v192
    v_cvt_pk_bf16_f32 v193, v193, v193
    v_and_b32 v193, 0xffff0000, v193
    v_mul_f32 v193, v193, v242
    v_cvt_pk_bf16_f32 v193, v193, v193
    v_and_b32 v193, 0xffff0000, v193
    v_cvt_pk_bf16_f32 v194, v194, v194
    v_and_b32 v194, 0xffff0000, v194
    v_mul_f32 v194, v194, v242
    v_cvt_pk_bf16_f32 v194, v194, v194
    v_and_b32 v194, 0xffff0000, v194
    v_cvt_pk_bf16_f32 v195, v195, v195
    v_and_b32 v195, 0xffff0000, v195
    v_mul_f32 v195, v195, v242
    v_cvt_pk_bf16_f32 v195, v195, v195
    v_and_b32 v195, 0xffff0000, v195
    ds_write_b32 v9, v192 offset:0
    ds_write_b32 v9, v193 offset:32
    ds_write_b32 v9, v194 offset:64
    ds_write_b32 v9, v195 offset:96
    v_mov_b32 v8, 137280
    v_mov_b32 v9, 1
    ds_write_b32 v8, v9 offset:52
    s_waitcnt lgkmcnt(0)
L_51:
    buffer_load_dwordx4 v[160:163], v2, s[16:19], s56 offen sc1
    s_add_u32 s56, s56, 8192
    s_waitcnt vmcnt(8) lgkmcnt(8)
    v_mfma_f32_16x16x32_bf16 v[224:227], v[32:35], v[128:131], v[224:227]
    ds_read_b64_tr_b16 v[16:17], v252 offset:8192
    ds_read_b64_tr_b16 v[18:19], v252 offset:10240
    v_mfma_f32_16x16x32_bf16 v[228:231], v[36:39], v[128:131], v[228:231]
    ds_read_b64_tr_b16 v[20:21], v253 offset:8192
    ds_read_b64_tr_b16 v[22:23], v253 offset:10240
    v_mfma_f32_16x16x32_bf16 v[232:235], v[40:43], v[128:131], v[232:235]
    ds_read_b64_tr_b16 v[24:25], v254 offset:8192
    ds_read_b64_tr_b16 v[26:27], v254 offset:10240
    v_mfma_f32_16x16x32_bf16 v[236:239], v[44:47], v[128:131], v[236:239]
    ds_read_b64_tr_b16 v[28:29], v255 offset:8192
    ds_read_b64_tr_b16 v[30:31], v255 offset:10240
    buffer_load_dwordx4 v[164:167], v2, s[16:19], s56 offen sc1
    s_add_u32 s56, s56, 8192
    s_waitcnt vmcnt(8) lgkmcnt(8)
    v_mfma_f32_16x16x32_bf16 v[224:227], v[48:51], v[132:135], v[224:227]
    ds_read_b64_tr_b16 v[32:33], v252 offset:12288
    ds_read_b64_tr_b16 v[34:35], v252 offset:14336
    v_mfma_f32_16x16x32_bf16 v[228:231], v[52:55], v[132:135], v[228:231]
    ds_read_b64_tr_b16 v[36:37], v253 offset:12288
    ds_read_b64_tr_b16 v[38:39], v253 offset:14336
    v_mfma_f32_16x16x32_bf16 v[232:235], v[56:59], v[132:135], v[232:235]
    ds_read_b64_tr_b16 v[40:41], v254 offset:12288
    ds_read_b64_tr_b16 v[42:43], v254 offset:14336
    v_mfma_f32_16x16x32_bf16 v[236:239], v[60:63], v[132:135], v[236:239]
    ds_read_b64_tr_b16 v[44:45], v255 offset:12288
    ds_read_b64_tr_b16 v[46:47], v255 offset:14336
    buffer_load_dwordx4 v[168:171], v2, s[16:19], s56 offen sc1
    s_add_u32 s56, s56, 8192
    s_waitcnt vmcnt(8) lgkmcnt(8)
    v_mfma_f32_16x16x32_bf16 v[224:227], v[16:19], v[136:139], v[224:227]
    ds_read_b64_tr_b16 v[48:49], v252 offset:16384
    ds_read_b64_tr_b16 v[50:51], v252 offset:18432
    v_mfma_f32_16x16x32_bf16 v[228:231], v[20:23], v[136:139], v[228:231]
    ds_read_b64_tr_b16 v[52:53], v253 offset:16384
    ds_read_b64_tr_b16 v[54:55], v253 offset:18432
    v_mfma_f32_16x16x32_bf16 v[232:235], v[24:27], v[136:139], v[232:235]
    ds_read_b64_tr_b16 v[56:57], v254 offset:16384
    ds_read_b64_tr_b16 v[58:59], v254 offset:18432
    v_mfma_f32_16x16x32_bf16 v[236:239], v[28:31], v[136:139], v[236:239]
    ds_read_b64_tr_b16 v[60:61], v255 offset:16384
    ds_read_b64_tr_b16 v[62:63], v255 offset:18432
    buffer_load_dwordx4 v[172:175], v2, s[16:19], s56 offen sc1
    s_add_u32 s56, s56, 8192
    s_waitcnt vmcnt(8) lgkmcnt(8)
    v_mfma_f32_16x16x32_bf16 v[224:227], v[32:35], v[140:143], v[224:227]
    ds_read_b64_tr_b16 v[16:17], v252 offset:20480
    ds_read_b64_tr_b16 v[18:19], v252 offset:22528
    v_mfma_f32_16x16x32_bf16 v[228:231], v[36:39], v[140:143], v[228:231]
    ds_read_b64_tr_b16 v[20:21], v253 offset:20480
    ds_read_b64_tr_b16 v[22:23], v253 offset:22528
    v_mfma_f32_16x16x32_bf16 v[232:235], v[40:43], v[140:143], v[232:235]
    ds_read_b64_tr_b16 v[24:25], v254 offset:20480
    ds_read_b64_tr_b16 v[26:27], v254 offset:22528
    v_mfma_f32_16x16x32_bf16 v[236:239], v[44:47], v[140:143], v[236:239]
    ds_read_b64_tr_b16 v[28:29], v255 offset:20480
    ds_read_b64_tr_b16 v[30:31], v255 offset:22528
    buffer_load_dwordx4 v[176:179], v2, s[16:19], s56 offen sc1
    s_add_u32 s56, s56, 8192
    s_waitcnt vmcnt(8) lgkmcnt(8)
    v_mfma_f32_16x16x32_bf16 v[224:227], v[48:51], v[144:147], v[224:227]
    ds_read_b64_tr_b16 v[32:33], v252 offset:24576
    ds_read_b64_tr_b16 v[34:35], v252 offset:26624
    v_mfma_f32_16x16x32_bf16 v[228:231], v[52:55], v[144:147], v[228:231]
    ds_read_b64_tr_b16 v[36:37], v253 offset:24576
    ds_read_b64_tr_b16 v[38:39], v253 offset:26624
    v_mfma_f32_16x16x32_bf16 v[232:235], v[56:59], v[144:147], v[232:235]
    ds_read_b64_tr_b16 v[40:41], v254 offset:24576
    ds_read_b64_tr_b16 v[42:43], v254 offset:26624
    v_mfma_f32_16x16x32_bf16 v[236:239], v[60:63], v[144:147], v[236:239]
    ds_read_b64_tr_b16 v[44:45], v255 offset:24576
    ds_read_b64_tr_b16 v[46:47], v255 offset:26624
    buffer_load_dwordx4 v[180:183], v2, s[16:19], s56 offen sc1
    s_add_u32 s56, s56, 8192
    s_waitcnt vmcnt(8) lgkmcnt(8)
    v_mfma_f32_16x16x32_bf16 v[224:227], v[16:19], v[148:151], v[224:227]
    ds_read_b64_tr_b16 v[48:49], v252 offset:28672
    ds_read_b64_tr_b16 v[50:51], v252 offset:30720
    v_mfma_f32_16x16x32_bf16 v[228:231], v[20:23], v[148:151], v[228:231]
    ds_read_b64_tr_b16 v[52:53], v253 offset:28672
    ds_read_b64_tr_b16 v[54:55], v253 offset:30720
    v_mfma_f32_16x16x32_bf16 v[232:235], v[24:27], v[148:151], v[232:235]
    ds_read_b64_tr_b16 v[56:57], v254 offset:28672
    ds_read_b64_tr_b16 v[58:59], v254 offset:30720
    v_mfma_f32_16x16x32_bf16 v[236:239], v[28:31], v[148:151], v[236:239]
    ds_read_b64_tr_b16 v[60:61], v255 offset:28672
    ds_read_b64_tr_b16 v[62:63], v255 offset:30720
    buffer_load_dwordx4 v[184:187], v2, s[16:19], s56 offen sc1
    s_add_u32 s56, s56, 8192
    s_waitcnt vmcnt(8) lgkmcnt(8)
    v_mfma_f32_16x16x32_bf16 v[224:227], v[32:35], v[152:155], v[224:227]
    ds_read_b64_tr_b16 v[16:17], v252 offset:32768
    ds_read_b64_tr_b16 v[18:19], v252 offset:34816
    v_mfma_f32_16x16x32_bf16 v[228:231], v[36:39], v[152:155], v[228:231]
    ds_read_b64_tr_b16 v[20:21], v253 offset:32768
    ds_read_b64_tr_b16 v[22:23], v253 offset:34816
    v_mfma_f32_16x16x32_bf16 v[232:235], v[40:43], v[152:155], v[232:235]
    ds_read_b64_tr_b16 v[24:25], v254 offset:32768
    ds_read_b64_tr_b16 v[26:27], v254 offset:34816
    v_mfma_f32_16x16x32_bf16 v[236:239], v[44:47], v[152:155], v[236:239]
    ds_read_b64_tr_b16 v[28:29], v255 offset:32768
    ds_read_b64_tr_b16 v[30:31], v255 offset:34816
    buffer_load_dwordx4 v[188:191], v2, s[16:19], s56 offen sc1
    s_add_u32 s56, s56, 8192
    s_waitcnt vmcnt(8) lgkmcnt(8)
    v_mfma_f32_16x16x32_bf16 v[224:227], v[48:51], v[156:159], v[224:227]
    ds_read_b64_tr_b16 v[32:33], v252 offset:36864
    ds_read_b64_tr_b16 v[34:35], v252 offset:38912
    v_mfma_f32_16x16x32_bf16 v[228:231], v[52:55], v[156:159], v[228:231]
    ds_read_b64_tr_b16 v[36:37], v253 offset:36864
    ds_read_b64_tr_b16 v[38:39], v253 offset:38912
    v_mfma_f32_16x16x32_bf16 v[232:235], v[56:59], v[156:159], v[232:235]
    ds_read_b64_tr_b16 v[40:41], v254 offset:36864
    ds_read_b64_tr_b16 v[42:43], v254 offset:38912
    v_mfma_f32_16x16x32_bf16 v[236:239], v[60:63], v[156:159], v[236:239]
    ds_read_b64_tr_b16 v[44:45], v255 offset:36864
    ds_read_b64_tr_b16 v[46:47], v255 offset:38912
    s_waitcnt vmcnt(7) lgkmcnt(8)
    v_mfma_f32_16x16x32_bf16 v[224:227], v[16:19], v[160:163], v[224:227]
    ds_read_b64_tr_b16 v[48:49], v252 offset:40960
    ds_read_b64_tr_b16 v[50:51], v252 offset:43008
    v_mfma_f32_16x16x32_bf16 v[228:231], v[20:23], v[160:163], v[228:231]
    ds_read_b64_tr_b16 v[52:53], v253 offset:40960
    ds_read_b64_tr_b16 v[54:55], v253 offset:43008
    v_mfma_f32_16x16x32_bf16 v[232:235], v[24:27], v[160:163], v[232:235]
    ds_read_b64_tr_b16 v[56:57], v254 offset:40960
    ds_read_b64_tr_b16 v[58:59], v254 offset:43008
    v_mfma_f32_16x16x32_bf16 v[236:239], v[28:31], v[160:163], v[236:239]
    ds_read_b64_tr_b16 v[60:61], v255 offset:40960
    ds_read_b64_tr_b16 v[62:63], v255 offset:43008
    s_waitcnt vmcnt(6) lgkmcnt(8)
    v_mfma_f32_16x16x32_bf16 v[224:227], v[32:35], v[164:167], v[224:227]
    ds_read_b64_tr_b16 v[16:17], v252 offset:45056
    ds_read_b64_tr_b16 v[18:19], v252 offset:47104
    v_mfma_f32_16x16x32_bf16 v[228:231], v[36:39], v[164:167], v[228:231]
    ds_read_b64_tr_b16 v[20:21], v253 offset:45056
    ds_read_b64_tr_b16 v[22:23], v253 offset:47104
    v_mfma_f32_16x16x32_bf16 v[232:235], v[40:43], v[164:167], v[232:235]
    ds_read_b64_tr_b16 v[24:25], v254 offset:45056
    ds_read_b64_tr_b16 v[26:27], v254 offset:47104
    v_mfma_f32_16x16x32_bf16 v[236:239], v[44:47], v[164:167], v[236:239]
    ds_read_b64_tr_b16 v[28:29], v255 offset:45056
    ds_read_b64_tr_b16 v[30:31], v255 offset:47104
    s_waitcnt vmcnt(5) lgkmcnt(8)
    v_mfma_f32_16x16x32_bf16 v[224:227], v[48:51], v[168:171], v[224:227]
    ds_read_b64_tr_b16 v[32:33], v252 offset:49152
    ds_read_b64_tr_b16 v[34:35], v252 offset:51200
    v_mfma_f32_16x16x32_bf16 v[228:231], v[52:55], v[168:171], v[228:231]
    ds_read_b64_tr_b16 v[36:37], v253 offset:49152
    ds_read_b64_tr_b16 v[38:39], v253 offset:51200
    v_mfma_f32_16x16x32_bf16 v[232:235], v[56:59], v[168:171], v[232:235]
    ds_read_b64_tr_b16 v[40:41], v254 offset:49152
    ds_read_b64_tr_b16 v[42:43], v254 offset:51200
    v_mfma_f32_16x16x32_bf16 v[236:239], v[60:63], v[168:171], v[236:239]
    ds_read_b64_tr_b16 v[44:45], v255 offset:49152
    ds_read_b64_tr_b16 v[46:47], v255 offset:51200
    s_waitcnt vmcnt(4) lgkmcnt(8)
    v_mfma_f32_16x16x32_bf16 v[224:227], v[16:19], v[172:175], v[224:227]
    ds_read_b64_tr_b16 v[48:49], v252 offset:53248
    ds_read_b64_tr_b16 v[50:51], v252 offset:55296
    v_mfma_f32_16x16x32_bf16 v[228:231], v[20:23], v[172:175], v[228:231]
    ds_read_b64_tr_b16 v[52:53], v253 offset:53248
    ds_read_b64_tr_b16 v[54:55], v253 offset:55296
    v_mfma_f32_16x16x32_bf16 v[232:235], v[24:27], v[172:175], v[232:235]
    ds_read_b64_tr_b16 v[56:57], v254 offset:53248
    ds_read_b64_tr_b16 v[58:59], v254 offset:55296
    v_mfma_f32_16x16x32_bf16 v[236:239], v[28:31], v[172:175], v[236:239]
    ds_read_b64_tr_b16 v[60:61], v255 offset:53248
    ds_read_b64_tr_b16 v[62:63], v255 offset:55296
    s_waitcnt vmcnt(3) lgkmcnt(8)
    v_mfma_f32_16x16x32_bf16 v[224:227], v[32:35], v[176:179], v[224:227]
    ds_read_b64_tr_b16 v[16:17], v252 offset:57344
    ds_read_b64_tr_b16 v[18:19], v252 offset:59392
    v_mfma_f32_16x16x32_bf16 v[228:231], v[36:39], v[176:179], v[228:231]
    ds_read_b64_tr_b16 v[20:21], v253 offset:57344
    ds_read_b64_tr_b16 v[22:23], v253 offset:59392
    v_mfma_f32_16x16x32_bf16 v[232:235], v[40:43], v[176:179], v[232:235]
    ds_read_b64_tr_b16 v[24:25], v254 offset:57344
    ds_read_b64_tr_b16 v[26:27], v254 offset:59392
    v_mfma_f32_16x16x32_bf16 v[236:239], v[44:47], v[176:179], v[236:239]
    ds_read_b64_tr_b16 v[28:29], v255 offset:57344
    ds_read_b64_tr_b16 v[30:31], v255 offset:59392
    s_waitcnt vmcnt(2) lgkmcnt(8)
    v_mfma_f32_16x16x32_bf16 v[224:227], v[48:51], v[180:183], v[224:227]
    ds_read_b64_tr_b16 v[32:33], v252 offset:61440
    ds_read_b64_tr_b16 v[34:35], v252 offset:63488
    v_mfma_f32_16x16x32_bf16 v[228:231], v[52:55], v[180:183], v[228:231]
    ds_read_b64_tr_b16 v[36:37], v253 offset:61440
    ds_read_b64_tr_b16 v[38:39], v253 offset:63488
    v_mfma_f32_16x16x32_bf16 v[232:235], v[56:59], v[180:183], v[232:235]
    ds_read_b64_tr_b16 v[40:41], v254 offset:61440
    ds_read_b64_tr_b16 v[42:43], v254 offset:63488
    v_mfma_f32_16x16x32_bf16 v[236:239], v[60:63], v[180:183], v[236:239]
    ds_read_b64_tr_b16 v[44:45], v255 offset:61440
    ds_read_b64_tr_b16 v[46:47], v255 offset:63488
    s_waitcnt vmcnt(1) lgkmcnt(8)
    v_mfma_f32_16x16x32_bf16 v[224:227], v[16:19], v[184:187], v[224:227]
    v_mfma_f32_16x16x32_bf16 v[228:231], v[20:23], v[184:187], v[228:231]
    v_mfma_f32_16x16x32_bf16 v[232:235], v[24:27], v[184:187], v[232:235]
    v_mfma_f32_16x16x32_bf16 v[236:239], v[28:31], v[184:187], v[236:239]
    s_waitcnt vmcnt(0) lgkmcnt(0)
    v_mfma_f32_16x16x32_bf16 v[224:227], v[32:35], v[188:191], v[224:227]
    v_mfma_f32_16x16x32_bf16 v[228:231], v[36:39], v[188:191], v[228:231]
    v_mfma_f32_16x16x32_bf16 v[232:235], v[40:43], v[188:191], v[232:235]
    v_mfma_f32_16x16x32_bf16 v[236:239], v[44:47], v[188:191], v[236:239]
    s_cmp_lg_u32 s57, s25
    s_cbranch_scc1 L_noupd
    v_mov_b32 v8, 137280
    v_add_u32 v245, 138496, v245
    s_mov_b32 s39, 1048576
LW_54:
    ds_read_b32 v9, v8 offset:52
    s_waitcnt lgkmcnt(0)
    v_cmp_eq_u32 vcc, 0, v9
    s_cbranch_vccz LE_55
    s_sleep 1
    s_sub_u32 s39, s39, 1
    s_cbranch_scc0 LW_54
LE_55:
    ds_read_b128 v[16:19], v245 offset:0
    ds_read_b128 v[20:23], v245 offset:64
    ds_read_b128 v[24:27], v245 offset:128
    ds_read_b128 v[28:31], v245 offset:192
    s_and_b32 s55, s55, 127
    v_cmp_eq_u32 vcc, s55, v247
    v_mov_b32 v14, 0
    v_mov_b32 v3, 1.0
    s_waitcnt lgkmcnt(0)
    v_cndmask_b32 v14, v14, v3, vcc
    v_fmac_f32 v224, v14, v16
    v_fmac_f32 v225, v14, v17
    v_fmac_f32 v226, v14, v18
    v_fmac_f32 v227, v14, v19
    v_fmac_f32 v228, v14, v20
    v_fmac_f32 v229, v14, v21
    v_fmac_f32 v230, v14, v22
    v_fmac_f32 v231, v14, v23
    v_fmac_f32 v232, v14, v24
    v_fmac_f32 v233, v14, v25
    v_fmac_f32 v234, v14, v26
    v_fmac_f32 v235, v14, v27
    v_fmac_f32 v236, v14, v28
    v_fmac_f32 v237, v14, v29
    v_fmac_f32 v238, v14, v30
    v_fmac_f32 v239, v14, v31
L_noupd:
    v_and_b32 v4, 8, v0
    v_lshlrev_b32 v5, 11, v4
    v_lshlrev_b32 v4, 3, v4
    v_sub_u32 v246, v246, v5
    v_add_u32 v246, v246, v4
    s_mov_b32 s30, 16384
    v_cvt_pk_bf16_f32 v48, v224, v225
    v_cvt_pk_bf16_f32 v49, v226, v227
    v_cvt_pk_bf16_f32 v50, v228, v229
    v_cvt_pk_bf16_f32 v51, v230, v231
    v_cvt_pk_bf16_f32 v52, v232, v233
    v_cvt_pk_bf16_f32 v53, v234, v235
    v_cvt_pk_bf16_f32 v54, v236, v237
    v_cvt_pk_bf16_f32 v55, v238, v239
    s_nop 0
    v_permlane16_swap_b32 v48, v50
    v_permlane16_swap_b32 v49, v51
    v_permlane16_swap_b32 v52, v54
    v_permlane16_swap_b32 v53, v55
    v_mov_b32 v56, v48
    v_mov_b32 v57, v49
    v_mov_b32 v58, v50
    v_mov_b32 v59, v51
    v_mov_b32_dpp v48, v52 row_ror:8 row_mask:0xf bank_mask:0xc
    v_mov_b32_dpp v49, v53 row_ror:8 row_mask:0xf bank_mask:0xc
    v_mov_b32_dpp v50, v54 row_ror:8 row_mask:0xf bank_mask:0xc
    v_mov_b32_dpp v51, v55 row_ror:8 row_mask:0xf bank_mask:0xc
    buffer_store_dwordx4 v[48:51], v246, s[40:43], 0 offen nt
    v_mov_b32_dpp v52, v56 row_ror:8 row_mask:0xf bank_mask:0x3
    v_mov_b32_dpp v53, v57 row_ror:8 row_mask:0xf bank_mask:0x3
    v_mov_b32_dpp v54, v58 row_ror:8 row_mask:0xf bank_mask:0x3
    v_mov_b32_dpp v55, v59 row_ror:8 row_mask:0xf bank_mask:0x3
    buffer_store_dwordx4 v[52:55], v246, s[40:43], s30 offen nt
    s_endpgm
L_end:
    s_endpgm
.section .rodata,"a"
.p2align 6
.amdhsa_kernel parallel_sum__linear_attn_block__moe_arch_mod__prompt_kernel
  .amdhsa_next_free_vgpr 256
  .amdhsa_next_free_sgpr 102
  .amdhsa_accum_offset 256
  .amdhsa_group_segment_fixed_size 0
  .amdhsa_kernarg_size 88
  .amdhsa_user_sgpr_count 2
  .amdhsa_user_sgpr_kernarg_segment_ptr 1
  .amdhsa_system_sgpr_workgroup_id_x 1
  .amdhsa_float_denorm_mode_32 3
.end_amdhsa_kernel
```
